```python
import torch

def _softmax(x, axis=-1):
    return torch.softmax(x, dim=axis)
def _gelu(x):
    return torch.nn.functional.gelu(x, approximate="tanh")
def _silu(x):
    return torch.nn.functional.silu(x)
def _sigmoid(x):
    return torch.sigmoid(x)
def _layernorm(x, axis=-1, eps=1e-5):
    m = x.mean(dim=axis, keepdim=True)
    v = x.var(dim=axis, keepdim=True, unbiased=False)
    return (x - m) / torch.sqrt(v + eps)
def _scatter_add(tgt, idx, src, axis=0):
    return tgt.clone().index_add_(axis, idx, src)
def _segment_sum(src, seg, n):
    out = torch.zeros((n,) + src.shape[1:], dtype=src.dtype)
    return out.index_add_(0, seg, src)
def _pad(x, pw):
    flat = tuple(v for pair in reversed(pw) for v in pair)
    return torch.nn.functional.pad(x, flat)

kernel_name = 'recurrent_scan__sliding_block_cached__swiglu_ffn__decode'

def setup_inputs():

    _w = (lambda a: (lambda t: t.to(torch.bfloat16) if t.is_floating_point() else t)(torch.as_tensor(a)))
    def _A_setup():
        B, Sq, D = 1, 1, 576
        Hq, Hkv, Sk, Dh = 32, 16, 16384, 128
        assert Hq % Hkv == 0, (Hq, Hkv)
        return {
            "x": _w((lambda *s: torch.randn(*s, dtype=torch.bfloat16) * 0.05)(B, Sq, D)),
            "k_cache": _w((lambda *s: torch.randn(*s, dtype=torch.bfloat16) * 1.6)(B, Hkv, Sk, Dh)),
            "v_cache": _w((lambda *s: torch.randn(*s, dtype=torch.bfloat16) * 0.2)(B, Hkv, Sk, Dh)),
            "wq": _w((lambda *s: torch.randn(*s, dtype=torch.bfloat16) * 1.6)(D, Hq * Dh) * (D ** -0.5)),
            "wo": _w((lambda *s: torch.randn(*s, dtype=torch.bfloat16) * 0.2)(Hq * Dh, D) * ((Hq * Dh) ** -0.5)),
        }
    _A_in = _A_setup()

    def _B_setup():
        B, S, D, F = 1, 1, 576, 4608
        return {
            "x": _w((lambda *s: torch.randn(*s, dtype=torch.bfloat16) * 0.05)(B, S, D)),
            "w_gate": _w((lambda *s: torch.randn(*s, dtype=torch.bfloat16) * 0.1)(D, F)),
            "w_up": _w((lambda *s: torch.randn(*s, dtype=torch.bfloat16) * 0.1)(D, F)),
            "w_down": _w((lambda *s: torch.randn(*s, dtype=torch.bfloat16) * 0.1)(F, D)),
        }
    _B_in = _B_setup()

    return {
        "A_x": _A_in["x"],
        "A_k_cache": _A_in["k_cache"],
        "A_v_cache": _A_in["v_cache"],
        "A_wq": _A_in["wq"],
        "A_wo": _A_in["wo"],
        "B_x": _B_in["x"],
        "B_w_gate": _B_in["w_gate"],
        "B_w_up": _B_in["w_up"],
        "B_w_down": _B_in["w_down"],
    }

def reference(A_x, A_k_cache, A_v_cache, A_wq, A_wo, B_x, B_w_gate, B_w_up, B_w_down):
    def _A_ref(x, k_cache, v_cache, wq, wo):
        B, Sq, D = x.shape
        Hq, Dh = 32, 128
        Hkv, Sk = k_cache.shape[1], k_cache.shape[2]
        W = min(4096, max(256, Sk // 4))
        rep = Hq // Hkv
        q = (lambda x, *d: x.permute(*d))((x @ wq).reshape(B, Sq, Hq, Dh), 0, 2, 1, 3)
        k = (lambda x, n, axis: torch.repeat_interleave(x, n, dim=axis))(k_cache[:, :, Sk - W:, :], rep, axis=1)
        v = (lambda x, n, axis: torch.repeat_interleave(x, n, dim=axis))(v_cache[:, :, Sk - W:, :], rep, axis=1)
        scores = torch.einsum("bhqd,bhkd->bhqk", q, k) * (Dh ** -0.5)
        p = _softmax(scores, axis=-1)
        o = torch.einsum("bhqk,bhkd->bhqd", p, v)
        return (lambda x, *d: x.permute(*d))(o, 0, 2, 1, 3).reshape(B, Sq, Hq * Dh) @ wo

    def _B_ref(x, w_gate, w_up, w_down):
        g = _silu(x @ w_gate)
        u = x @ w_up
        return (g * u) @ w_down

    x = A_x
    xn = _layernorm(x, axis=-1)
    s = _A_ref(xn, A_k_cache, A_v_cache, A_wq, A_wo)
    g = _silu(_B_ref(xn, B_w_gate, B_w_up, B_w_down))
    return x + s * g
```

```asm
; @launch grid=(256,1,1) block=(768,1,1) lds=43008
.amdgcn_target "amdgcn-amd-amdhsa--gfx950"
.text
.globl recurrent_scan__sliding_block_cached__swiglu_ffn__decode_kernel
.p2align 8
.type recurrent_scan__sliding_block_cached__swiglu_ffn__decode_kernel,@function
recurrent_scan__sliding_block_cached__swiglu_ffn__decode_kernel:
    s_load_dwordx2 s[8:9], s[0:1], 0
    s_load_dwordx2 s[12:13], s[0:1], 8
    s_load_dwordx2 s[16:17], s[0:1], 16
    s_load_dwordx2 s[20:21], s[0:1], 24
    s_load_dwordx2 s[24:25], s[0:1], 32
    s_load_dwordx2 s[28:29], s[0:1], 48
    s_load_dwordx2 s[32:33], s[0:1], 56
    s_load_dwordx2 s[36:37], s[0:1], 64
    s_load_dwordx2 s[40:41], s[0:1], 72
    s_load_dwordx2 s[44:45], s[0:1], 88
    v_lshrrev_b32 v2, 6, v0
    v_and_b32 v1, 63, v0
    v_readfirstlane_b32 s3, v2
    s_cmp_ge_u32 s2, 256
    s_nop 2
    s_cbranch_scc1 L_end_recurrent_scan__sliding_block_cached__swiglu_ffn__decode_kernel
    s_mov_b32 s10, 0x480
    s_mov_b32 s11, 0x20000
    s_mov_b32 s14, 0x4000000
    s_mov_b32 s15, 0x20000
    s_mov_b32 s18, 0x4000000
    s_mov_b32 s19, 0x20000
    s_mov_b32 s22, 0x480000
    s_mov_b32 s23, 0x20000
    s_mov_b32 s26, 0x480000
    s_mov_b32 s27, 0x20000
    s_mov_b32 s30, 0x510000
    s_mov_b32 s31, 0x20000
    s_mov_b32 s34, 0x510000
    s_mov_b32 s35, 0x20000
    s_mov_b32 s38, 0x510000
    s_mov_b32 s39, 0x20000
    s_mov_b32 s42, 0x480
    s_mov_b32 s43, 0x20000
    s_mov_b32 s46, 0x400000
    s_mov_b32 s47, 0x20000
    s_mov_b32 s50, 0x05040100
    s_mov_b32 s51, 0x07060302
    s_mov_b32 s52, 0xcccccccc
    s_mov_b32 s53, 0xcccccccc
    s_mov_b32 s54, 0xaaaaaaaa
    s_mov_b32 s55, 0xaaaaaaaa
    s_mov_b32 s56, -1
    s_mov_b32 s57, 0
    s_cmp_lg_u32 s3, 0
    s_cbranch_scc1 L_nz_1
    v_mov_b32 v3, 0
    v_lshlrev_b32 v4, 2, v1
    ds_write_b32 v4, v3
L_nz_1:
    s_waitcnt lgkmcnt(0)
    s_cmp_lg_u32 s3, 8
    s_cbranch_scc1 L_noq_2
    v_mov_b32 v142, 0
    buffer_load_dwordx2 v[140:141], v142, s[44:47], 0 offen offset:0 sc1
    v_lshlrev_b32 v125, 2, v1
    buffer_load_dword v120, v125, s[8:11], 0 offen offset:0
    buffer_load_dword v121, v125, s[8:11], 0 offen offset:256
    buffer_load_dword v122, v125, s[8:11], 0 offen offset:512
    buffer_load_dword v123, v125, s[8:11], 0 offen offset:768
    buffer_load_dword v124, v125, s[8:11], 0 offen offset:1024
    s_and_b32 s66, s2, 3
    s_lshr_b32 s68, s2, 4
    s_lshl_b32 s68, s68, 2
    s_add_u32 s68, s68, s66
    s_lshl_b32 s66, s68, 7
    s_bfe_u32 s69, s2, 0x20002
    s_mul_i32 s70, s69, 1179648
    s_add_u32 s66, s66, s70
    v_lshrrev_b32 v130, 3, v1
    s_mov_b32 s63, 8192
    v_mul_lo_u32 v130, v130, s63
    v_and_b32 v131, 7, v1
    v_lshl_add_u32 v130, v131, 4, v130
    buffer_load_dwordx4 v[8:11], v130, s[20:23], s66 offen nt
    s_add_u32 s66, s66, 65536
    buffer_load_dwordx4 v[12:15], v130, s[20:23], s66 offen nt
    s_add_u32 s66, s66, 65536
    buffer_load_dwordx4 v[16:19], v130, s[20:23], s66 offen nt
    s_add_u32 s66, s66, 65536
    buffer_load_dwordx4 v[20:23], v130, s[20:23], s66 offen nt
    s_add_u32 s66, s66, 65536
    buffer_load_dwordx4 v[24:27], v130, s[20:23], s66 offen nt
    s_add_u32 s66, s66, 65536
    buffer_load_dwordx4 v[28:31], v130, s[20:23], s66 offen nt
    s_add_u32 s66, s66, 65536
    buffer_load_dwordx4 v[32:35], v130, s[20:23], s66 offen nt
    s_add_u32 s66, s66, 65536
    buffer_load_dwordx4 v[36:39], v130, s[20:23], s66 offen nt
    s_add_u32 s66, s66, 65536
    buffer_load_dwordx4 v[40:43], v130, s[20:23], s66 offen nt
    s_add_u32 s66, s66, 65536
    buffer_load_dwordx4 v[44:47], v130, s[20:23], s66 offen nt
    s_add_u32 s66, s66, 65536
    buffer_load_dwordx4 v[48:51], v130, s[20:23], s66 offen nt
    s_add_u32 s66, s66, 65536
    buffer_load_dwordx4 v[52:55], v130, s[20:23], s66 offen nt
    s_add_u32 s66, s66, 65536
    buffer_load_dwordx4 v[56:59], v130, s[20:23], s66 offen nt
    s_add_u32 s66, s66, 65536
    buffer_load_dwordx4 v[60:63], v130, s[20:23], s66 offen nt
    s_add_u32 s66, s66, 65536
    buffer_load_dwordx4 v[64:67], v130, s[20:23], s66 offen nt
    s_add_u32 s66, s66, 65536
    buffer_load_dwordx4 v[68:71], v130, s[20:23], s66 offen nt
    s_add_u32 s66, s66, 65536
    buffer_load_dwordx4 v[72:75], v130, s[20:23], s66 offen nt
    s_add_u32 s66, s66, 65536
    buffer_load_dwordx4 v[76:79], v130, s[20:23], s66 offen nt
L_noq_2:
    s_waitcnt lgkmcnt(0)
    s_barrier
    s_cmp_ge_u32 s3, 8
    s_cbranch_scc1 L_twave_3
    s_lshr_b32 s66, s2, 4
    s_lshl_b32 s66, s66, 22
    s_and_b32 s67, s2, 15
    s_lshl_b32 s67, s67, 16
    s_add_u32 s66, s66, s67
    s_lshl_b32 s67, s3, 13
    s_add_u32 s66, s66, s67
    s_add_u32 s66, s66, 0x300000
    s_add_u32 s67, s66, 4096
    v_lshlrev_b32 v112, 4, v1
    s_mul_i32 s82, s3, 1
    s_add_u32 s74, s82, 0
    s_and_b32 s74, s74, 7
    s_lshl_b32 s74, s74, 10
    s_add_u32 s74, s74, s66
    s_add_u32 s75, s82, 1
    s_and_b32 s75, s75, 7
    s_lshl_b32 s75, s75, 10
    s_add_u32 s75, s75, s66
    s_add_u32 s76, s82, 2
    s_and_b32 s76, s76, 7
    s_lshl_b32 s76, s76, 10
    s_add_u32 s76, s76, s66
    s_add_u32 s77, s82, 3
    s_and_b32 s77, s77, 7
    s_lshl_b32 s77, s77, 10
    s_add_u32 s77, s77, s66
    s_add_u32 s78, s82, 4
    s_and_b32 s78, s78, 7
    s_lshl_b32 s78, s78, 10
    s_add_u32 s78, s78, s66
    s_add_u32 s79, s82, 5
    s_and_b32 s79, s79, 7
    s_lshl_b32 s79, s79, 10
    s_add_u32 s79, s79, s66
    s_add_u32 s80, s82, 6
    s_and_b32 s80, s80, 7
    s_lshl_b32 s80, s80, 10
    s_add_u32 s80, s80, s66
    s_add_u32 s81, s82, 7
    s_and_b32 s81, s81, 7
    s_lshl_b32 s81, s81, 10
    s_add_u32 s81, s81, s66
    buffer_load_dwordx4 v[8:11], v112, s[12:15], s74 offen nt
    buffer_load_dwordx4 v[12:15], v112, s[12:15], s75 offen nt
    buffer_load_dwordx4 v[16:19], v112, s[12:15], s76 offen nt
    buffer_load_dwordx4 v[20:23], v112, s[12:15], s77 offen nt
    s_waitcnt vmcnt(3)
    buffer_load_dwordx4 v[24:27], v112, s[12:15], s78 offen nt
    s_waitcnt vmcnt(3)
    buffer_load_dwordx4 v[28:31], v112, s[12:15], s79 offen nt
    s_waitcnt vmcnt(3)
    buffer_load_dwordx4 v[32:35], v112, s[12:15], s80 offen nt
    s_waitcnt vmcnt(3)
    buffer_load_dwordx4 v[36:39], v112, s[12:15], s81 offen nt
    s_waitcnt vmcnt(3)
    buffer_load_dwordx4 v[40:43], v112, s[16:19], s74 offen nt
    s_waitcnt vmcnt(3)
    buffer_load_dwordx4 v[44:47], v112, s[16:19], s75 offen nt
    s_waitcnt vmcnt(3)
    buffer_load_dwordx4 v[48:51], v112, s[16:19], s76 offen nt
    s_waitcnt vmcnt(3)
    buffer_load_dwordx4 v[52:55], v112, s[16:19], s77 offen nt
    s_waitcnt vmcnt(3)
    buffer_load_dwordx4 v[56:59], v112, s[16:19], s78 offen nt
    s_waitcnt vmcnt(3)
    buffer_load_dwordx4 v[60:63], v112, s[16:19], s79 offen nt
    s_waitcnt vmcnt(3)
    buffer_load_dwordx4 v[64:67], v112, s[16:19], s80 offen nt
    s_waitcnt vmcnt(3)
    buffer_load_dwordx4 v[68:71], v112, s[16:19], s81 offen nt
    v_mov_b32 v114, 0
    v_mov_b32 v115, 1
    s_mov_b64 exec, 1
    ds_add_u32 v114, v115 offset:4
    s_mov_b64 exec, -1
    v_mov_b32 v115, 0
    s_mov_b32 s58, 0
L_lw_4:
    ds_read_b32 v114, v115 offset:0
    s_add_u32 s58, s58, 1
    s_waitcnt lgkmcnt(0)
    v_readfirstlane_b32 s62, v114
    s_nop 1
    s_cmp_ge_u32 s62, 1
    s_nop 0
    s_cbranch_scc1 L_lwd_5
    s_sleep 1
    s_cmp_lt_u32 s58, 0x400000
    s_cbranch_scc1 L_lw_4
L_lwd_5:
    v_and_b32 v114, 15, v1
    v_lshlrev_b32 v114, 4, v114
    ds_read_b128 v[72:75], v114 offset:256
    ds_read_b128 v[76:79], v114 offset:512
    s_waitcnt lgkmcnt(1)
    v_dot2_f32_bf16 v80, v8, v72, 0
    v_dot2c_f32_bf16 v80, v9, v73
    v_dot2c_f32_bf16 v80, v10, v74
    v_dot2c_f32_bf16 v80, v11, v75
    s_waitcnt lgkmcnt(0)
    v_dot2_f32_bf16 v81, v8, v76, 0
    v_dot2c_f32_bf16 v81, v9, v77
    v_dot2c_f32_bf16 v81, v10, v78
    v_dot2c_f32_bf16 v81, v11, v79
    v_dot2_f32_bf16 v82, v12, v72, 0
    v_dot2c_f32_bf16 v82, v13, v73
    v_dot2c_f32_bf16 v82, v14, v74
    v_dot2c_f32_bf16 v82, v15, v75
    v_dot2_f32_bf16 v83, v12, v76, 0
    v_dot2c_f32_bf16 v83, v13, v77
    v_dot2c_f32_bf16 v83, v14, v78
    v_dot2c_f32_bf16 v83, v15, v79
    v_dot2_f32_bf16 v84, v16, v72, 0
    v_dot2c_f32_bf16 v84, v17, v73
    v_dot2c_f32_bf16 v84, v18, v74
    v_dot2c_f32_bf16 v84, v19, v75
    v_dot2_f32_bf16 v85, v16, v76, 0
    v_dot2c_f32_bf16 v85, v17, v77
    v_dot2c_f32_bf16 v85, v18, v78
    v_dot2c_f32_bf16 v85, v19, v79
    v_dot2_f32_bf16 v86, v20, v72, 0
    v_dot2c_f32_bf16 v86, v21, v73
    v_dot2c_f32_bf16 v86, v22, v74
    v_dot2c_f32_bf16 v86, v23, v75
    v_dot2_f32_bf16 v87, v20, v76, 0
    v_dot2c_f32_bf16 v87, v21, v77
    v_dot2c_f32_bf16 v87, v22, v78
    v_dot2c_f32_bf16 v87, v23, v79
    v_dot2_f32_bf16 v88, v24, v72, 0
    v_dot2c_f32_bf16 v88, v25, v73
    v_dot2c_f32_bf16 v88, v26, v74
    v_dot2c_f32_bf16 v88, v27, v75
    v_dot2_f32_bf16 v89, v24, v76, 0
    v_dot2c_f32_bf16 v89, v25, v77
    v_dot2c_f32_bf16 v89, v26, v78
    v_dot2c_f32_bf16 v89, v27, v79
    v_dot2_f32_bf16 v90, v28, v72, 0
    v_dot2c_f32_bf16 v90, v29, v73
    v_dot2c_f32_bf16 v90, v30, v74
    v_dot2c_f32_bf16 v90, v31, v75
    v_dot2_f32_bf16 v91, v28, v76, 0
    v_dot2c_f32_bf16 v91, v29, v77
    v_dot2c_f32_bf16 v91, v30, v78
    v_dot2c_f32_bf16 v91, v31, v79
    v_dot2_f32_bf16 v92, v32, v72, 0
    v_dot2c_f32_bf16 v92, v33, v73
    v_dot2c_f32_bf16 v92, v34, v74
    v_dot2c_f32_bf16 v92, v35, v75
    v_dot2_f32_bf16 v93, v32, v76, 0
    v_dot2c_f32_bf16 v93, v33, v77
    v_dot2c_f32_bf16 v93, v34, v78
    v_dot2c_f32_bf16 v93, v35, v79
    v_dot2_f32_bf16 v94, v36, v72, 0
    v_dot2c_f32_bf16 v94, v37, v73
    v_dot2c_f32_bf16 v94, v38, v74
    v_dot2c_f32_bf16 v94, v39, v75
    v_dot2_f32_bf16 v95, v36, v76, 0
    v_dot2c_f32_bf16 v95, v37, v77
    v_dot2c_f32_bf16 v95, v38, v78
    v_dot2c_f32_bf16 v95, v39, v79
    v_add_f32_dpp v80, v80, v80 row_ror:8 row_mask:0xf bank_mask:0x3
    s_nop 1
    v_add_f32_dpp v80, v88, v88 row_ror:8 row_mask:0xf bank_mask:0xc
    v_add_f32_dpp v81, v81, v81 row_ror:8 row_mask:0xf bank_mask:0x3
    s_nop 1
    v_add_f32_dpp v81, v89, v89 row_ror:8 row_mask:0xf bank_mask:0xc
    v_add_f32_dpp v82, v82, v82 row_ror:8 row_mask:0xf bank_mask:0x3
    s_nop 1
    v_add_f32_dpp v82, v90, v90 row_ror:8 row_mask:0xf bank_mask:0xc
    v_add_f32_dpp v83, v83, v83 row_ror:8 row_mask:0xf bank_mask:0x3
    s_nop 1
    v_add_f32_dpp v83, v91, v91 row_ror:8 row_mask:0xf bank_mask:0xc
    v_add_f32_dpp v84, v84, v84 row_ror:8 row_mask:0xf bank_mask:0x3
    s_nop 1
    v_add_f32_dpp v84, v92, v92 row_ror:8 row_mask:0xf bank_mask:0xc
    v_add_f32_dpp v85, v85, v85 row_ror:8 row_mask:0xf bank_mask:0x3
    s_nop 1
    v_add_f32_dpp v85, v93, v93 row_ror:8 row_mask:0xf bank_mask:0xc
    v_add_f32_dpp v86, v86, v86 row_ror:8 row_mask:0xf bank_mask:0x3
    s_nop 1
    v_add_f32_dpp v86, v94, v94 row_ror:8 row_mask:0xf bank_mask:0xc
    v_add_f32_dpp v87, v87, v87 row_ror:8 row_mask:0xf bank_mask:0x3
    s_nop 1
    v_add_f32_dpp v87, v95, v95 row_ror:8 row_mask:0xf bank_mask:0xc
    v_add_f32_dpp v80, v80, v80 row_shl:4 row_mask:0xf bank_mask:0x5
    s_nop 1
    v_add_f32_dpp v80, v84, v84 row_shr:4 row_mask:0xf bank_mask:0xa
    v_add_f32_dpp v81, v81, v81 row_shl:4 row_mask:0xf bank_mask:0x5
    s_nop 1
    v_add_f32_dpp v81, v85, v85 row_shr:4 row_mask:0xf bank_mask:0xa
    v_add_f32_dpp v82, v82, v82 row_shl:4 row_mask:0xf bank_mask:0x5
    s_nop 1
    v_add_f32_dpp v82, v86, v86 row_shr:4 row_mask:0xf bank_mask:0xa
    v_add_f32_dpp v83, v83, v83 row_shl:4 row_mask:0xf bank_mask:0x5
    s_nop 1
    v_add_f32_dpp v83, v87, v87 row_shr:4 row_mask:0xf bank_mask:0xa
    v_add_f32_dpp v80, v80, v80 quad_perm:[2,3,0,1] row_mask:0xf bank_mask:0xf
    v_add_f32_dpp v82, v82, v82 quad_perm:[2,3,0,1] row_mask:0xf bank_mask:0xf
    v_cndmask_b32 v80, v80, v82, s[52:53]
    v_add_f32_dpp v81, v81, v81 quad_perm:[2,3,0,1] row_mask:0xf bank_mask:0xf
    v_add_f32_dpp v83, v83, v83 quad_perm:[2,3,0,1] row_mask:0xf bank_mask:0xf
    v_cndmask_b32 v81, v81, v83, s[52:53]
    v_add_f32_dpp v80, v80, v80 quad_perm:[1,0,3,2] row_mask:0xf bank_mask:0xf
    s_nop 0
    v_add_f32_dpp v81, v81, v81 quad_perm:[1,0,3,2] row_mask:0xf bank_mask:0xf
    v_cndmask_b32 v80, v80, v81, s[54:55]
    v_cvt_pk_bf16_f32 v80, v80, v80
    v_lshlrev_b32 v80, 16, v80
    v_mul_f32 v80, 0x3db504f3, v80
    v_cvt_pk_bf16_f32 v80, v80, v80
    v_lshlrev_b32 v80, 16, v80
    s_nop 1
    v_max_f32_dpp v81, v80, v80 quad_perm:[2,3,0,1] row_mask:0xf bank_mask:0xf
    s_nop 1
    v_max_f32_dpp v81, v81, v81 row_ror:4 row_mask:0xf bank_mask:0xf
    s_nop 1
    v_max_f32_dpp v81, v81, v81 row_ror:8 row_mask:0xf bank_mask:0xf
    v_mov_b32 v82, v81
    s_nop 1
    v_permlane16_swap_b32 v81, v82
    v_max_f32 v81, v81, v82
    v_mov_b32 v82, v81
    s_nop 1
    v_permlane32_swap_b32 v81, v82
    v_max_f32 v81, v81, v82
    v_sub_f32 v83, v80, v81
    v_mul_f32 v83, 0x3fb8aa3b, v83
    v_exp_f32 v83, v83
    s_nop 1
    v_add_f32_dpp v84, v83, v83 quad_perm:[2,3,0,1] row_mask:0xf bank_mask:0xf
    s_nop 1
    v_add_f32_dpp v84, v84, v84 row_ror:4 row_mask:0xf bank_mask:0xf
    s_nop 1
    v_add_f32_dpp v84, v84, v84 row_ror:8 row_mask:0xf bank_mask:0xf
    v_mov_b32 v82, v84
    s_nop 1
    v_permlane16_swap_b32 v84, v82
    v_add_f32 v84, v84, v82
    v_mov_b32 v82, v84
    s_nop 1
    v_permlane32_swap_b32 v84, v82
    v_add_f32 v84, v84, v82
    v_mov_b32 v125, 0
    s_mov_b32 s58, 0
L_lw_6:
    ds_read_b32 v124, v125 offset:12
    s_add_u32 s58, s58, 1
    s_waitcnt lgkmcnt(0)
    v_readfirstlane_b32 s62, v124
    s_nop 1
    s_cmp_ge_u32 s62, 1
    s_nop 0
    s_cbranch_scc1 L_lwd_7
    s_sleep 1
    s_cmp_lt_u32 s58, 0x400000
    s_cbranch_scc1 L_lw_6
L_lwd_7:
    v_mov_b32 v126, 0
    ds_read_b64 v[124:125], v126 offset:16
    s_waitcnt lgkmcnt(0)
    v_readfirstlane_b32 s48, v124
    v_readfirstlane_b32 s49, v125
    s_nop 0
    v_mov_b32 v130, s48
    v_mov_b32 v131, s49
    v_mov_b32 v134, s48
    v_mov_b32 v135, s49
    v_mov_b32 v142, s48
    v_mov_b32 v143, s49
    v_lshrrev_b32 v136, 5, v1
    v_lshlrev_b32 v136, 14, v136
    v_and_b32 v137, 15, v1
    v_lshl_add_u32 v136, v137, 6, v136
    v_bfe_u32 v137, v1, 4, 1
    v_lshl_add_u32 v136, v137, 5, v136
    v_lshrrev_b32 v138, 5, v1
    v_lshlrev_b32 v138, 8, v138
    s_lshr_b32 s70, s2, 4
    s_lshl_b32 s70, s70, 5
    s_and_b32 s71, s2, 15
    s_add_u32 s70, s70, s71
    s_lshl_b32 s71, s70, 10
    s_add_u32 s71, s71, 0x100000
    s_lshl_b32 s72, s70, 4
    s_add_u32 s72, s72, 0x180000
    v_lshrrev_b32 v125, 5, v1
    v_lshlrev_b32 v125, 3, v125
    v_lshlrev_b32 v86, 16, v40
    v_and_b32 v87, 0xffff0000, v40
    s_nop 0
    v_mul_f32_dpp v96, v83, v86 row_newbcast:0 row_mask:0xf bank_mask:0xf
    v_mul_f32_dpp v97, v83, v87 row_newbcast:0 row_mask:0xf bank_mask:0xf
    v_mul_f32_dpp v104, v83, v86 row_newbcast:1 row_mask:0xf bank_mask:0xf
    v_mul_f32_dpp v105, v83, v87 row_newbcast:1 row_mask:0xf bank_mask:0xf
    v_lshlrev_b32 v86, 16, v41
    v_and_b32 v87, 0xffff0000, v41
    s_nop 0
    v_mul_f32_dpp v98, v83, v86 row_newbcast:0 row_mask:0xf bank_mask:0xf
    v_mul_f32_dpp v99, v83, v87 row_newbcast:0 row_mask:0xf bank_mask:0xf
    v_mul_f32_dpp v106, v83, v86 row_newbcast:1 row_mask:0xf bank_mask:0xf
    v_mul_f32_dpp v107, v83, v87 row_newbcast:1 row_mask:0xf bank_mask:0xf
    v_lshlrev_b32 v86, 16, v42
    v_and_b32 v87, 0xffff0000, v42
    s_nop 0
    v_mul_f32_dpp v100, v83, v86 row_newbcast:0 row_mask:0xf bank_mask:0xf
    v_mul_f32_dpp v101, v83, v87 row_newbcast:0 row_mask:0xf bank_mask:0xf
    v_mul_f32_dpp v108, v83, v86 row_newbcast:1 row_mask:0xf bank_mask:0xf
    v_mul_f32_dpp v109, v83, v87 row_newbcast:1 row_mask:0xf bank_mask:0xf
    v_lshlrev_b32 v86, 16, v43
    v_and_b32 v87, 0xffff0000, v43
    s_nop 0
    v_mul_f32_dpp v102, v83, v86 row_newbcast:0 row_mask:0xf bank_mask:0xf
    v_mul_f32_dpp v103, v83, v87 row_newbcast:0 row_mask:0xf bank_mask:0xf
    v_mul_f32_dpp v110, v83, v86 row_newbcast:1 row_mask:0xf bank_mask:0xf
    v_mul_f32_dpp v111, v83, v87 row_newbcast:1 row_mask:0xf bank_mask:0xf
    v_lshlrev_b32 v86, 16, v44
    v_and_b32 v87, 0xffff0000, v44
    s_nop 0
    v_fmac_f32_dpp v96, v83, v86 row_newbcast:2 row_mask:0xf bank_mask:0xf
    v_fmac_f32_dpp v97, v83, v87 row_newbcast:2 row_mask:0xf bank_mask:0xf
    v_fmac_f32_dpp v104, v83, v86 row_newbcast:3 row_mask:0xf bank_mask:0xf
    v_fmac_f32_dpp v105, v83, v87 row_newbcast:3 row_mask:0xf bank_mask:0xf
    v_lshlrev_b32 v86, 16, v45
    v_and_b32 v87, 0xffff0000, v45
    s_nop 0
    v_fmac_f32_dpp v98, v83, v86 row_newbcast:2 row_mask:0xf bank_mask:0xf
    v_fmac_f32_dpp v99, v83, v87 row_newbcast:2 row_mask:0xf bank_mask:0xf
    v_fmac_f32_dpp v106, v83, v86 row_newbcast:3 row_mask:0xf bank_mask:0xf
    v_fmac_f32_dpp v107, v83, v87 row_newbcast:3 row_mask:0xf bank_mask:0xf
    v_lshlrev_b32 v86, 16, v46
    v_and_b32 v87, 0xffff0000, v46
    s_nop 0
    v_fmac_f32_dpp v100, v83, v86 row_newbcast:2 row_mask:0xf bank_mask:0xf
    v_fmac_f32_dpp v101, v83, v87 row_newbcast:2 row_mask:0xf bank_mask:0xf
    v_fmac_f32_dpp v108, v83, v86 row_newbcast:3 row_mask:0xf bank_mask:0xf
    v_fmac_f32_dpp v109, v83, v87 row_newbcast:3 row_mask:0xf bank_mask:0xf
    v_lshlrev_b32 v86, 16, v47
    v_and_b32 v87, 0xffff0000, v47
    s_nop 0
    v_fmac_f32_dpp v102, v83, v86 row_newbcast:2 row_mask:0xf bank_mask:0xf
    v_fmac_f32_dpp v103, v83, v87 row_newbcast:2 row_mask:0xf bank_mask:0xf
    v_fmac_f32_dpp v110, v83, v86 row_newbcast:3 row_mask:0xf bank_mask:0xf
    v_fmac_f32_dpp v111, v83, v87 row_newbcast:3 row_mask:0xf bank_mask:0xf
    v_lshlrev_b32 v86, 16, v48
    v_and_b32 v87, 0xffff0000, v48
    s_nop 0
    v_fmac_f32_dpp v96, v83, v86 row_newbcast:4 row_mask:0xf bank_mask:0xf
    v_fmac_f32_dpp v97, v83, v87 row_newbcast:4 row_mask:0xf bank_mask:0xf
    v_fmac_f32_dpp v104, v83, v86 row_newbcast:5 row_mask:0xf bank_mask:0xf
    v_fmac_f32_dpp v105, v83, v87 row_newbcast:5 row_mask:0xf bank_mask:0xf
    v_lshlrev_b32 v86, 16, v49
    v_and_b32 v87, 0xffff0000, v49
    s_nop 0
    v_fmac_f32_dpp v98, v83, v86 row_newbcast:4 row_mask:0xf bank_mask:0xf
    v_fmac_f32_dpp v99, v83, v87 row_newbcast:4 row_mask:0xf bank_mask:0xf
    v_fmac_f32_dpp v106, v83, v86 row_newbcast:5 row_mask:0xf bank_mask:0xf
    v_fmac_f32_dpp v107, v83, v87 row_newbcast:5 row_mask:0xf bank_mask:0xf
    v_lshlrev_b32 v86, 16, v50
    v_and_b32 v87, 0xffff0000, v50
    s_nop 0
    v_fmac_f32_dpp v100, v83, v86 row_newbcast:4 row_mask:0xf bank_mask:0xf
    v_fmac_f32_dpp v101, v83, v87 row_newbcast:4 row_mask:0xf bank_mask:0xf
    v_fmac_f32_dpp v108, v83, v86 row_newbcast:5 row_mask:0xf bank_mask:0xf
    v_fmac_f32_dpp v109, v83, v87 row_newbcast:5 row_mask:0xf bank_mask:0xf
    v_lshlrev_b32 v86, 16, v51
    v_and_b32 v87, 0xffff0000, v51
    s_nop 0
    v_fmac_f32_dpp v102, v83, v86 row_newbcast:4 row_mask:0xf bank_mask:0xf
    v_fmac_f32_dpp v103, v83, v87 row_newbcast:4 row_mask:0xf bank_mask:0xf
    v_fmac_f32_dpp v110, v83, v86 row_newbcast:5 row_mask:0xf bank_mask:0xf
    v_fmac_f32_dpp v111, v83, v87 row_newbcast:5 row_mask:0xf bank_mask:0xf
    v_lshlrev_b32 v86, 16, v52
    v_and_b32 v87, 0xffff0000, v52
    s_nop 0
    v_fmac_f32_dpp v96, v83, v86 row_newbcast:6 row_mask:0xf bank_mask:0xf
    v_fmac_f32_dpp v97, v83, v87 row_newbcast:6 row_mask:0xf bank_mask:0xf
    v_fmac_f32_dpp v104, v83, v86 row_newbcast:7 row_mask:0xf bank_mask:0xf
    v_fmac_f32_dpp v105, v83, v87 row_newbcast:7 row_mask:0xf bank_mask:0xf
    v_lshlrev_b32 v86, 16, v53
    v_and_b32 v87, 0xffff0000, v53
    s_nop 0
    v_fmac_f32_dpp v98, v83, v86 row_newbcast:6 row_mask:0xf bank_mask:0xf
    v_fmac_f32_dpp v99, v83, v87 row_newbcast:6 row_mask:0xf bank_mask:0xf
    v_fmac_f32_dpp v106, v83, v86 row_newbcast:7 row_mask:0xf bank_mask:0xf
    v_fmac_f32_dpp v107, v83, v87 row_newbcast:7 row_mask:0xf bank_mask:0xf
    v_lshlrev_b32 v86, 16, v54
    v_and_b32 v87, 0xffff0000, v54
    s_nop 0
    v_fmac_f32_dpp v100, v83, v86 row_newbcast:6 row_mask:0xf bank_mask:0xf
    v_fmac_f32_dpp v101, v83, v87 row_newbcast:6 row_mask:0xf bank_mask:0xf
    v_fmac_f32_dpp v108, v83, v86 row_newbcast:7 row_mask:0xf bank_mask:0xf
    v_fmac_f32_dpp v109, v83, v87 row_newbcast:7 row_mask:0xf bank_mask:0xf
    v_lshlrev_b32 v86, 16, v55
    v_and_b32 v87, 0xffff0000, v55
    s_nop 0
    v_fmac_f32_dpp v102, v83, v86 row_newbcast:6 row_mask:0xf bank_mask:0xf
    v_fmac_f32_dpp v103, v83, v87 row_newbcast:6 row_mask:0xf bank_mask:0xf
    v_fmac_f32_dpp v110, v83, v86 row_newbcast:7 row_mask:0xf bank_mask:0xf
    v_fmac_f32_dpp v111, v83, v87 row_newbcast:7 row_mask:0xf bank_mask:0xf
    s_waitcnt vmcnt(3)
    v_lshlrev_b32 v86, 16, v56
    v_and_b32 v87, 0xffff0000, v56
    s_nop 0
    v_fmac_f32_dpp v96, v83, v86 row_newbcast:8 row_mask:0xf bank_mask:0xf
    v_fmac_f32_dpp v97, v83, v87 row_newbcast:8 row_mask:0xf bank_mask:0xf
    v_fmac_f32_dpp v104, v83, v86 row_newbcast:9 row_mask:0xf bank_mask:0xf
    v_fmac_f32_dpp v105, v83, v87 row_newbcast:9 row_mask:0xf bank_mask:0xf
    v_lshlrev_b32 v86, 16, v57
    v_and_b32 v87, 0xffff0000, v57
    s_nop 0
    v_fmac_f32_dpp v98, v83, v86 row_newbcast:8 row_mask:0xf bank_mask:0xf
    v_fmac_f32_dpp v99, v83, v87 row_newbcast:8 row_mask:0xf bank_mask:0xf
    v_fmac_f32_dpp v106, v83, v86 row_newbcast:9 row_mask:0xf bank_mask:0xf
    v_fmac_f32_dpp v107, v83, v87 row_newbcast:9 row_mask:0xf bank_mask:0xf
    v_lshlrev_b32 v86, 16, v58
    v_and_b32 v87, 0xffff0000, v58
    s_nop 0
    v_fmac_f32_dpp v100, v83, v86 row_newbcast:8 row_mask:0xf bank_mask:0xf
    v_fmac_f32_dpp v101, v83, v87 row_newbcast:8 row_mask:0xf bank_mask:0xf
    v_fmac_f32_dpp v108, v83, v86 row_newbcast:9 row_mask:0xf bank_mask:0xf
    v_fmac_f32_dpp v109, v83, v87 row_newbcast:9 row_mask:0xf bank_mask:0xf
    v_lshlrev_b32 v86, 16, v59
    v_and_b32 v87, 0xffff0000, v59
    s_nop 0
    v_fmac_f32_dpp v102, v83, v86 row_newbcast:8 row_mask:0xf bank_mask:0xf
    v_fmac_f32_dpp v103, v83, v87 row_newbcast:8 row_mask:0xf bank_mask:0xf
    v_fmac_f32_dpp v110, v83, v86 row_newbcast:9 row_mask:0xf bank_mask:0xf
    v_fmac_f32_dpp v111, v83, v87 row_newbcast:9 row_mask:0xf bank_mask:0xf
    s_waitcnt vmcnt(2)
    v_lshlrev_b32 v86, 16, v60
    v_and_b32 v87, 0xffff0000, v60
    s_nop 0
    v_fmac_f32_dpp v96, v83, v86 row_newbcast:10 row_mask:0xf bank_mask:0xf
    v_fmac_f32_dpp v97, v83, v87 row_newbcast:10 row_mask:0xf bank_mask:0xf
    v_fmac_f32_dpp v104, v83, v86 row_newbcast:11 row_mask:0xf bank_mask:0xf
    v_fmac_f32_dpp v105, v83, v87 row_newbcast:11 row_mask:0xf bank_mask:0xf
    v_lshlrev_b32 v86, 16, v61
    v_and_b32 v87, 0xffff0000, v61
    s_nop 0
    v_fmac_f32_dpp v98, v83, v86 row_newbcast:10 row_mask:0xf bank_mask:0xf
    v_fmac_f32_dpp v99, v83, v87 row_newbcast:10 row_mask:0xf bank_mask:0xf
    v_fmac_f32_dpp v106, v83, v86 row_newbcast:11 row_mask:0xf bank_mask:0xf
    v_fmac_f32_dpp v107, v83, v87 row_newbcast:11 row_mask:0xf bank_mask:0xf
    v_lshlrev_b32 v86, 16, v62
    v_and_b32 v87, 0xffff0000, v62
    s_nop 0
    v_fmac_f32_dpp v100, v83, v86 row_newbcast:10 row_mask:0xf bank_mask:0xf
    v_fmac_f32_dpp v101, v83, v87 row_newbcast:10 row_mask:0xf bank_mask:0xf
    v_fmac_f32_dpp v108, v83, v86 row_newbcast:11 row_mask:0xf bank_mask:0xf
    v_fmac_f32_dpp v109, v83, v87 row_newbcast:11 row_mask:0xf bank_mask:0xf
    v_lshlrev_b32 v86, 16, v63
    v_and_b32 v87, 0xffff0000, v63
    s_nop 0
    v_fmac_f32_dpp v102, v83, v86 row_newbcast:10 row_mask:0xf bank_mask:0xf
    v_fmac_f32_dpp v103, v83, v87 row_newbcast:10 row_mask:0xf bank_mask:0xf
    v_fmac_f32_dpp v110, v83, v86 row_newbcast:11 row_mask:0xf bank_mask:0xf
    v_fmac_f32_dpp v111, v83, v87 row_newbcast:11 row_mask:0xf bank_mask:0xf
    s_waitcnt vmcnt(1)
    v_lshlrev_b32 v86, 16, v64
    v_and_b32 v87, 0xffff0000, v64
    s_nop 0
    v_fmac_f32_dpp v96, v83, v86 row_newbcast:12 row_mask:0xf bank_mask:0xf
    v_fmac_f32_dpp v97, v83, v87 row_newbcast:12 row_mask:0xf bank_mask:0xf
    v_fmac_f32_dpp v104, v83, v86 row_newbcast:13 row_mask:0xf bank_mask:0xf
    v_fmac_f32_dpp v105, v83, v87 row_newbcast:13 row_mask:0xf bank_mask:0xf
    v_lshlrev_b32 v86, 16, v65
    v_and_b32 v87, 0xffff0000, v65
    s_nop 0
    v_fmac_f32_dpp v98, v83, v86 row_newbcast:12 row_mask:0xf bank_mask:0xf
    v_fmac_f32_dpp v99, v83, v87 row_newbcast:12 row_mask:0xf bank_mask:0xf
    v_fmac_f32_dpp v106, v83, v86 row_newbcast:13 row_mask:0xf bank_mask:0xf
    v_fmac_f32_dpp v107, v83, v87 row_newbcast:13 row_mask:0xf bank_mask:0xf
    v_lshlrev_b32 v86, 16, v66
    v_and_b32 v87, 0xffff0000, v66
    s_nop 0
    v_fmac_f32_dpp v100, v83, v86 row_newbcast:12 row_mask:0xf bank_mask:0xf
    v_fmac_f32_dpp v101, v83, v87 row_newbcast:12 row_mask:0xf bank_mask:0xf
    v_fmac_f32_dpp v108, v83, v86 row_newbcast:13 row_mask:0xf bank_mask:0xf
    v_fmac_f32_dpp v109, v83, v87 row_newbcast:13 row_mask:0xf bank_mask:0xf
    v_lshlrev_b32 v86, 16, v67
    v_and_b32 v87, 0xffff0000, v67
    s_nop 0
    v_fmac_f32_dpp v102, v83, v86 row_newbcast:12 row_mask:0xf bank_mask:0xf
    v_fmac_f32_dpp v103, v83, v87 row_newbcast:12 row_mask:0xf bank_mask:0xf
    v_fmac_f32_dpp v110, v83, v86 row_newbcast:13 row_mask:0xf bank_mask:0xf
    v_fmac_f32_dpp v111, v83, v87 row_newbcast:13 row_mask:0xf bank_mask:0xf
    s_waitcnt vmcnt(0)
    v_lshlrev_b32 v86, 16, v68
    v_and_b32 v87, 0xffff0000, v68
    s_nop 0
    v_fmac_f32_dpp v96, v83, v86 row_newbcast:14 row_mask:0xf bank_mask:0xf
    v_fmac_f32_dpp v97, v83, v87 row_newbcast:14 row_mask:0xf bank_mask:0xf
    v_fmac_f32_dpp v104, v83, v86 row_newbcast:15 row_mask:0xf bank_mask:0xf
    v_fmac_f32_dpp v105, v83, v87 row_newbcast:15 row_mask:0xf bank_mask:0xf
    v_lshlrev_b32 v86, 16, v69
    v_and_b32 v87, 0xffff0000, v69
    s_nop 0
    v_fmac_f32_dpp v98, v83, v86 row_newbcast:14 row_mask:0xf bank_mask:0xf
    v_fmac_f32_dpp v99, v83, v87 row_newbcast:14 row_mask:0xf bank_mask:0xf
    v_fmac_f32_dpp v106, v83, v86 row_newbcast:15 row_mask:0xf bank_mask:0xf
    v_fmac_f32_dpp v107, v83, v87 row_newbcast:15 row_mask:0xf bank_mask:0xf
    v_lshlrev_b32 v86, 16, v70
    v_and_b32 v87, 0xffff0000, v70
    s_nop 0
    v_fmac_f32_dpp v100, v83, v86 row_newbcast:14 row_mask:0xf bank_mask:0xf
    v_fmac_f32_dpp v101, v83, v87 row_newbcast:14 row_mask:0xf bank_mask:0xf
    v_fmac_f32_dpp v108, v83, v86 row_newbcast:15 row_mask:0xf bank_mask:0xf
    v_fmac_f32_dpp v109, v83, v87 row_newbcast:15 row_mask:0xf bank_mask:0xf
    v_lshlrev_b32 v86, 16, v71
    v_and_b32 v87, 0xffff0000, v71
    s_nop 0
    v_fmac_f32_dpp v102, v83, v86 row_newbcast:14 row_mask:0xf bank_mask:0xf
    v_fmac_f32_dpp v103, v83, v87 row_newbcast:14 row_mask:0xf bank_mask:0xf
    v_fmac_f32_dpp v110, v83, v86 row_newbcast:15 row_mask:0xf bank_mask:0xf
    v_fmac_f32_dpp v111, v83, v87 row_newbcast:15 row_mask:0xf bank_mask:0xf
    v_permlane32_swap_b32 v96, v104
    v_permlane32_swap_b32 v97, v105
    v_permlane32_swap_b32 v98, v106
    v_permlane32_swap_b32 v99, v107
    v_permlane32_swap_b32 v100, v108
    v_permlane32_swap_b32 v101, v109
    v_permlane32_swap_b32 v102, v110
    v_permlane32_swap_b32 v103, v111
    v_add_f32 v96, v96, v104
    v_add_f32 v97, v97, v105
    v_add_f32 v98, v98, v106
    v_add_f32 v99, v99, v107
    v_add_f32 v100, v100, v108
    v_add_f32 v101, v101, v109
    v_add_f32 v102, v102, v110
    v_add_f32 v103, v103, v111
    v_permlane16_swap_b32 v96, v100
    v_permlane16_swap_b32 v97, v101
    v_permlane16_swap_b32 v98, v102
    v_permlane16_swap_b32 v99, v103
    v_add_f32 v96, v96, v100
    v_add_f32 v97, v97, v101
    v_add_f32 v98, v98, v102
    v_add_f32 v99, v99, v103
    v_lshrrev_b32 v116, 5, v1
    v_lshlrev_b32 v116, 9, v116
    v_and_b32 v117, 15, v1
    v_lshl_add_u32 v116, v117, 5, v116
    v_bfe_u32 v117, v1, 4, 1
    v_lshl_add_u32 v116, v117, 4, v116
    s_lshl_b32 s68, s3, 10
    v_add_u32 v118, s68, v116
    ds_write_b128 v118, v[96:99] offset:2048
    v_mov_b32 v120, v81
    v_mov_b32 v121, v84
    v_lshlrev_b32 v119, 3, v1
    s_lshl_b32 s68, s3, 4
    v_add_u32 v119, s68, v119
    s_mov_b64 exec, 3
    ds_write_b64 v119, v[120:121] offset:1024
    s_mov_b64 exec, 1
    s_waitcnt lgkmcnt(0)
    v_mov_b32 v122, 0
    v_mov_b32 v123, 1
    ds_add_rtn_u32 v124, v122, v123 offset:8
    s_mov_b64 exec, -1
    s_waitcnt lgkmcnt(0)
    v_readfirstlane_b32 s68, v124
    s_nop 1
    s_cmp_lg_u32 s68, 7
    s_nop 0
    s_cbranch_scc1 L_exit_recurrent_scan__sliding_block_cached__swiglu_ffn__decode_kernel
    ds_read_b64 v[8:9], v125 offset:1024
    ds_read_b64 v[10:11], v125 offset:1040
    ds_read_b64 v[12:13], v125 offset:1056
    ds_read_b64 v[14:15], v125 offset:1072
    ds_read_b64 v[16:17], v125 offset:1088
    ds_read_b64 v[18:19], v125 offset:1104
    ds_read_b64 v[20:21], v125 offset:1120
    ds_read_b64 v[22:23], v125 offset:1136
    ds_read_b128 v[24:27], v116 offset:2048
    ds_read_b128 v[28:31], v116 offset:3072
    ds_read_b128 v[32:35], v116 offset:4096
    ds_read_b128 v[36:39], v116 offset:5120
    ds_read_b128 v[40:43], v116 offset:6144
    ds_read_b128 v[44:47], v116 offset:7168
    ds_read_b128 v[48:51], v116 offset:8192
    ds_read_b128 v[52:55], v116 offset:9216
    s_waitcnt lgkmcnt(13)
    v_max3_f32 v126, v8, v10, v12
    s_waitcnt lgkmcnt(11)
    v_max3_f32 v126, v126, v14, v16
    s_waitcnt lgkmcnt(9)
    v_max3_f32 v126, v126, v18, v20
    s_waitcnt lgkmcnt(8)
    v_max_f32 v126, v126, v22
    v_sub_f32 v8, v8, v126
    v_mul_f32 v8, 0x3fb8aa3b, v8
    v_exp_f32 v8, v8
    v_sub_f32 v10, v10, v126
    v_mul_f32 v10, 0x3fb8aa3b, v10
    v_exp_f32 v10, v10
    v_sub_f32 v12, v12, v126
    v_mul_f32 v12, 0x3fb8aa3b, v12
    v_exp_f32 v12, v12
    v_sub_f32 v14, v14, v126
    v_mul_f32 v14, 0x3fb8aa3b, v14
    v_exp_f32 v14, v14
    v_sub_f32 v16, v16, v126
    v_mul_f32 v16, 0x3fb8aa3b, v16
    v_exp_f32 v16, v16
    v_sub_f32 v18, v18, v126
    v_mul_f32 v18, 0x3fb8aa3b, v18
    v_exp_f32 v18, v18
    v_sub_f32 v20, v20, v126
    v_mul_f32 v20, 0x3fb8aa3b, v20
    v_exp_f32 v20, v20
    v_sub_f32 v22, v22, v126
    v_mul_f32 v22, 0x3fb8aa3b, v22
    v_exp_f32 v22, v22
    v_mul_f32 v127, v8, v9
    v_fmac_f32 v127, v10, v11
    v_fmac_f32 v127, v12, v13
    v_fmac_f32 v127, v14, v15
    v_fmac_f32 v127, v16, v17
    v_fmac_f32 v127, v18, v19
    v_fmac_f32 v127, v20, v21
    v_fmac_f32 v127, v22, v23
    s_waitcnt lgkmcnt(7)
    v_mul_f32 v128, v8, v24
    s_waitcnt lgkmcnt(6)
    v_fmac_f32 v128, v10, v28
    s_waitcnt lgkmcnt(5)
    v_fmac_f32 v128, v12, v32
    s_waitcnt lgkmcnt(4)
    v_fmac_f32 v128, v14, v36
    s_waitcnt lgkmcnt(3)
    v_fmac_f32 v128, v16, v40
    s_waitcnt lgkmcnt(2)
    v_fmac_f32 v128, v18, v44
    s_waitcnt lgkmcnt(1)
    v_fmac_f32 v128, v20, v48
    s_waitcnt lgkmcnt(0)
    v_fmac_f32 v128, v22, v52
    v_mul_f32 v129, v8, v25
    v_fmac_f32 v129, v10, v29
    v_fmac_f32 v129, v12, v33
    v_fmac_f32 v129, v14, v37
    v_fmac_f32 v129, v16, v41
    v_fmac_f32 v129, v18, v45
    v_fmac_f32 v129, v20, v49
    v_fmac_f32 v129, v22, v53
    v_mul_f32 v132, v8, v26
    v_fmac_f32 v132, v10, v30
    v_fmac_f32 v132, v12, v34
    v_fmac_f32 v132, v14, v38
    v_fmac_f32 v132, v16, v42
    v_fmac_f32 v132, v18, v46
    v_fmac_f32 v132, v20, v50
    v_fmac_f32 v132, v22, v54
    v_mul_f32 v133, v8, v27
    v_fmac_f32 v133, v10, v31
    v_fmac_f32 v133, v12, v35
    v_fmac_f32 v133, v14, v39
    v_fmac_f32 v133, v16, v43
    v_fmac_f32 v133, v18, v47
    v_fmac_f32 v133, v20, v51
    v_fmac_f32 v133, v22, v55
    v_mov_b32 v140, v126
    v_mov_b32 v141, v127
    buffer_store_dwordx4 v[128:131], v136, s[44:47], s71 offen sc1
    buffer_store_dwordx4 v[132:135], v136, s[44:47], s71 offen offset:16 sc1
    s_mov_b32 exec_lo, 1
    s_mov_b32 exec_hi, 1
    buffer_store_dwordx4 v[140:143], v138, s[44:47], s72 offen sc1
    s_mov_b64 exec, -1
    v_mov_b32 v114, 0
    v_mov_b32 v115, 1
    ds_write_b32 v114, v115 offset:28
    s_branch L_exit_recurrent_scan__sliding_block_cached__swiglu_ffn__decode_kernel
L_twave_3:
    s_cmp_lg_u32 s3, 8
    s_cbranch_scc1 L_t1_8
    s_waitcnt vmcnt(23)
    v_add_co_u32 v140, vcc, 1, v140
    s_nop 1
    v_addc_co_u32 v141, vcc, 0, v141, vcc
    v_readfirstlane_b32 s48, v140
    v_readfirstlane_b32 s49, v141
    v_mov_b32 v142, 0
    ds_write_b64 v142, v[140:141] offset:16
    s_waitcnt lgkmcnt(0)
    v_mov_b32 v143, 1
    ds_write_b32 v142, v143 offset:12
    s_mul_i32 s60, s3, 2560
    s_add_u32 s60, s60, 12288
    s_waitcnt vmcnt(22)
    v_lshlrev_b32 v80, 16, v120
    v_and_b32 v81, 0xffff0000, v120
    s_waitcnt vmcnt(21)
    v_lshlrev_b32 v82, 16, v121
    v_and_b32 v83, 0xffff0000, v121
    s_waitcnt vmcnt(20)
    v_lshlrev_b32 v84, 16, v122
    v_and_b32 v85, 0xffff0000, v122
    s_waitcnt vmcnt(19)
    v_lshlrev_b32 v86, 16, v123
    v_and_b32 v87, 0xffff0000, v123
    s_waitcnt vmcnt(18)
    v_lshlrev_b32 v88, 16, v124
    v_and_b32 v89, 0xffff0000, v124
    v_add_f32 v90, v80, v81
    v_add_f32 v90, v90, v82
    v_add_f32 v90, v90, v83
    v_add_f32 v90, v90, v84
    v_add_f32 v90, v90, v85
    v_add_f32 v90, v90, v86
    v_add_f32 v90, v90, v87
    v_add_f32 v90, v90, v88
    v_add_f32 v90, v90, v89
    s_nop 1
    v_add_f32_dpp v90, v90, v90 quad_perm:[1,0,3,2] row_mask:0xf bank_mask:0xf
    s_nop 1
    v_add_f32_dpp v90, v90, v90 quad_perm:[2,3,0,1] row_mask:0xf bank_mask:0xf
    s_nop 1
    v_add_f32_dpp v90, v90, v90 row_half_mirror row_mask:0xf bank_mask:0xf
    s_nop 1
    v_add_f32_dpp v90, v90, v90 row_mirror row_mask:0xf bank_mask:0xf
    v_mov_b32 v91, v90
    s_nop 1
    v_permlane16_swap_b32 v90, v91
    v_add_f32 v90, v90, v91
    v_mov_b32 v91, v90
    s_nop 1
    v_permlane32_swap_b32 v90, v91
    v_add_f32 v90, v90, v91
    v_mul_f32 v92, 0x3ae38e39, v90
    v_mov_b32 v93, 0
    v_sub_f32 v94, v80, v92
    v_fmac_f32 v93, v94, v94
    v_sub_f32 v94, v81, v92
    v_fmac_f32 v93, v94, v94
    v_sub_f32 v94, v82, v92
    v_fmac_f32 v93, v94, v94
    v_sub_f32 v94, v83, v92
    v_fmac_f32 v93, v94, v94
    v_sub_f32 v94, v84, v92
    v_fmac_f32 v93, v94, v94
    v_sub_f32 v94, v85, v92
    v_fmac_f32 v93, v94, v94
    v_sub_f32 v94, v86, v92
    v_fmac_f32 v93, v94, v94
    v_sub_f32 v94, v87, v92
    v_fmac_f32 v93, v94, v94
    v_sub_f32 v94, v88, v92
    v_cndmask_b32 v94, 0, v94, s[56:57]
    v_fmac_f32 v93, v94, v94
    v_sub_f32 v94, v89, v92
    v_cndmask_b32 v94, 0, v94, s[56:57]
    v_fmac_f32 v93, v94, v94
    s_nop 1
    v_add_f32_dpp v93, v93, v93 quad_perm:[1,0,3,2] row_mask:0xf bank_mask:0xf
    s_nop 1
    v_add_f32_dpp v93, v93, v93 quad_perm:[2,3,0,1] row_mask:0xf bank_mask:0xf
    s_nop 1
    v_add_f32_dpp v93, v93, v93 row_half_mirror row_mask:0xf bank_mask:0xf
    s_nop 1
    v_add_f32_dpp v93, v93, v93 row_mirror row_mask:0xf bank_mask:0xf
    v_mov_b32 v91, v93
    s_nop 1
    v_permlane16_swap_b32 v93, v91
    v_add_f32 v93, v93, v91
    v_mov_b32 v91, v93
    s_nop 1
    v_permlane32_swap_b32 v93, v91
    v_add_f32 v93, v93, v91
    v_mul_f32 v93, 0x3ae38e39, v93
    v_cvt_pk_bf16_f32 v95, v92, v92
    v_lshlrev_b32 v95, 16, v95
    v_cvt_pk_bf16_f32 v96, v93, v93
    v_lshlrev_b32 v96, 16, v96
    v_add_f32 v96, 0x3727c5ac, v96
    v_cvt_pk_bf16_f32 v96, v96, v96
    v_lshlrev_b32 v96, 16, v96
    v_sqrt_f32 v96, v96
    s_nop 0
    v_cvt_pk_bf16_f32 v96, v96, v96
    v_lshlrev_b32 v96, 16, v96
    v_rcp_f32 v97, v96
    v_lshrrev_b32 v98, 3, v1
    v_lshlrev_b32 v98, 5, v98
    v_and_b32 v99, 3, v1
    v_lshl_add_u32 v98, v99, 3, v98
    v_bfe_u32 v99, v1, 2, 1
    v_lshl_add_u32 v98, v99, 1, v98
    v_add_u32 v98, s60, v98
    v_sub_f32 v80, v80, v95
    v_sub_f32 v81, v81, v95
    v_cvt_pk_bf16_f32 v91, v80, v81
    v_lshlrev_b32 v80, 16, v91
    v_and_b32 v81, 0xffff0000, v91
    v_mul_f32 v100, v80, v97
    v_fma_f32 v101, -v100, v96, v80
    v_fma_f32 v80, v101, v97, v100
    v_mul_f32 v100, v81, v97
    v_fma_f32 v101, -v100, v96, v81
    v_fma_f32 v81, v101, v97, v100
    v_cvt_pk_bf16_f32 v91, v80, v81
    ds_write_b16 v98, v91 offset:0
    ds_write_b16_d16_hi v98, v91 offset:4
    v_sub_f32 v82, v82, v95
    v_sub_f32 v83, v83, v95
    v_cvt_pk_bf16_f32 v91, v82, v83
    v_lshlrev_b32 v82, 16, v91
    v_and_b32 v83, 0xffff0000, v91
    v_mul_f32 v100, v82, v97
    v_fma_f32 v101, -v100, v96, v82
    v_fma_f32 v82, v101, v97, v100
    v_mul_f32 v100, v83, v97
    v_fma_f32 v101, -v100, v96, v83
    v_fma_f32 v83, v101, v97, v100
    v_cvt_pk_bf16_f32 v91, v82, v83
    ds_write_b16 v98, v91 offset:256
    ds_write_b16_d16_hi v98, v91 offset:260
    v_sub_f32 v84, v84, v95
    v_sub_f32 v85, v85, v95
    v_cvt_pk_bf16_f32 v91, v84, v85
    v_lshlrev_b32 v84, 16, v91
    v_and_b32 v85, 0xffff0000, v91
    v_mul_f32 v100, v84, v97
    v_fma_f32 v101, -v100, v96, v84
    v_fma_f32 v84, v101, v97, v100
    v_mul_f32 v100, v85, v97
    v_fma_f32 v101, -v100, v96, v85
    v_fma_f32 v85, v101, v97, v100
    v_cvt_pk_bf16_f32 v91, v84, v85
    ds_write_b16 v98, v91 offset:512
    ds_write_b16_d16_hi v98, v91 offset:516
    v_sub_f32 v86, v86, v95
    v_sub_f32 v87, v87, v95
    v_cvt_pk_bf16_f32 v91, v86, v87
    v_lshlrev_b32 v86, 16, v91
    v_and_b32 v87, 0xffff0000, v91
    v_mul_f32 v100, v86, v97
    v_fma_f32 v101, -v100, v96, v86
    v_fma_f32 v86, v101, v97, v100
    v_mul_f32 v100, v87, v97
    v_fma_f32 v101, -v100, v96, v87
    v_fma_f32 v87, v101, v97, v100
    v_cvt_pk_bf16_f32 v91, v86, v87
    ds_write_b16 v98, v91 offset:768
    ds_write_b16_d16_hi v98, v91 offset:772
    v_sub_f32 v88, v88, v95
    v_sub_f32 v89, v89, v95
    v_cvt_pk_bf16_f32 v91, v88, v89
    v_lshlrev_b32 v88, 16, v91
    v_and_b32 v89, 0xffff0000, v91
    v_mul_f32 v100, v88, v97
    v_fma_f32 v101, -v100, v96, v88
    v_fma_f32 v88, v101, v97, v100
    v_mul_f32 v100, v89, v97
    v_fma_f32 v101, -v100, v96, v89
    v_fma_f32 v89, v101, v97, v100
    v_cvt_pk_bf16_f32 v91, v88, v89
    ds_write_b16 v98, v91 offset:1024
    ds_write_b16_d16_hi v98, v91 offset:1028
    s_mul_i32 s70, s69, 288
    s_add_u32 s70, s70, s60
    v_lshrrev_b32 v114, 3, v1
    v_lshlrev_b32 v114, 2, v114
    v_add_u32 v114, s70, v114
    ds_read_b32 v104, v114 offset:0
    ds_read_b32 v105, v114 offset:32
    ds_read_b32 v106, v114 offset:64
    ds_read_b32 v107, v114 offset:96
    ds_read_b32 v108, v114 offset:128
    ds_read_b32 v109, v114 offset:160
    ds_read_b32 v110, v114 offset:192
    ds_read_b32 v111, v114 offset:224
    ds_read_b32 v112, v114 offset:256
    s_waitcnt vmcnt(16)
    v_perm_b32 v114, v12, v8, s50
    v_perm_b32 v115, v12, v8, s51
    s_waitcnt lgkmcnt(8)
    v_dot2_f32_bf16 v152, v114, v104, 0
    v_dot2_f32_bf16 v153, v115, v104, 0
    v_perm_b32 v114, v13, v9, s50
    v_perm_b32 v115, v13, v9, s51
    v_dot2_f32_bf16 v154, v114, v104, 0
    v_dot2_f32_bf16 v155, v115, v104, 0
    v_perm_b32 v114, v14, v10, s50
    v_perm_b32 v115, v14, v10, s51
    v_dot2_f32_bf16 v156, v114, v104, 0
    v_dot2_f32_bf16 v157, v115, v104, 0
    v_perm_b32 v114, v15, v11, s50
    v_perm_b32 v115, v15, v11, s51
    v_dot2_f32_bf16 v158, v114, v104, 0
    v_dot2_f32_bf16 v159, v115, v104, 0
    s_waitcnt vmcnt(14)
    v_perm_b32 v114, v20, v16, s50
    v_perm_b32 v115, v20, v16, s51
    s_waitcnt lgkmcnt(7)
    v_dot2c_f32_bf16 v152, v114, v105
    v_dot2c_f32_bf16 v153, v115, v105
    v_perm_b32 v114, v21, v17, s50
    v_perm_b32 v115, v21, v17, s51
    v_dot2c_f32_bf16 v154, v114, v105
    v_dot2c_f32_bf16 v155, v115, v105
    v_perm_b32 v114, v22, v18, s50
    v_perm_b32 v115, v22, v18, s51
    v_dot2c_f32_bf16 v156, v114, v105
    v_dot2c_f32_bf16 v157, v115, v105
    v_perm_b32 v114, v23, v19, s50
    v_perm_b32 v115, v23, v19, s51
    v_dot2c_f32_bf16 v158, v114, v105
    v_dot2c_f32_bf16 v159, v115, v105
    s_waitcnt vmcnt(12)
    v_perm_b32 v114, v28, v24, s50
    v_perm_b32 v115, v28, v24, s51
    s_waitcnt lgkmcnt(6)
    v_dot2c_f32_bf16 v152, v114, v106
    v_dot2c_f32_bf16 v153, v115, v106
    v_perm_b32 v114, v29, v25, s50
    v_perm_b32 v115, v29, v25, s51
    v_dot2c_f32_bf16 v154, v114, v106
    v_dot2c_f32_bf16 v155, v115, v106
    v_perm_b32 v114, v30, v26, s50
    v_perm_b32 v115, v30, v26, s51
    v_dot2c_f32_bf16 v156, v114, v106
    v_dot2c_f32_bf16 v157, v115, v106
    v_perm_b32 v114, v31, v27, s50
    v_perm_b32 v115, v31, v27, s51
    v_dot2c_f32_bf16 v158, v114, v106
    v_dot2c_f32_bf16 v159, v115, v106
    s_waitcnt vmcnt(10)
    v_perm_b32 v114, v36, v32, s50
    v_perm_b32 v115, v36, v32, s51
    s_waitcnt lgkmcnt(5)
    v_dot2c_f32_bf16 v152, v114, v107
    v_dot2c_f32_bf16 v153, v115, v107
    v_perm_b32 v114, v37, v33, s50
    v_perm_b32 v115, v37, v33, s51
    v_dot2c_f32_bf16 v154, v114, v107
    v_dot2c_f32_bf16 v155, v115, v107
    v_perm_b32 v114, v38, v34, s50
    v_perm_b32 v115, v38, v34, s51
    v_dot2c_f32_bf16 v156, v114, v107
    v_dot2c_f32_bf16 v157, v115, v107
    v_perm_b32 v114, v39, v35, s50
    v_perm_b32 v115, v39, v35, s51
    v_dot2c_f32_bf16 v158, v114, v107
    v_dot2c_f32_bf16 v159, v115, v107
    s_waitcnt vmcnt(8)
    v_perm_b32 v114, v44, v40, s50
    v_perm_b32 v115, v44, v40, s51
    s_waitcnt lgkmcnt(4)
    v_dot2c_f32_bf16 v152, v114, v108
    v_dot2c_f32_bf16 v153, v115, v108
    v_perm_b32 v114, v45, v41, s50
    v_perm_b32 v115, v45, v41, s51
    v_dot2c_f32_bf16 v154, v114, v108
    v_dot2c_f32_bf16 v155, v115, v108
    v_perm_b32 v114, v46, v42, s50
    v_perm_b32 v115, v46, v42, s51
    v_dot2c_f32_bf16 v156, v114, v108
    v_dot2c_f32_bf16 v157, v115, v108
    v_perm_b32 v114, v47, v43, s50
    v_perm_b32 v115, v47, v43, s51
    v_dot2c_f32_bf16 v158, v114, v108
    v_dot2c_f32_bf16 v159, v115, v108
    s_waitcnt vmcnt(6)
    v_perm_b32 v114, v52, v48, s50
    v_perm_b32 v115, v52, v48, s51
    s_waitcnt lgkmcnt(3)
    v_dot2c_f32_bf16 v152, v114, v109
    v_dot2c_f32_bf16 v153, v115, v109
    v_perm_b32 v114, v53, v49, s50
    v_perm_b32 v115, v53, v49, s51
    v_dot2c_f32_bf16 v154, v114, v109
    v_dot2c_f32_bf16 v155, v115, v109
    v_perm_b32 v114, v54, v50, s50
    v_perm_b32 v115, v54, v50, s51
    v_dot2c_f32_bf16 v156, v114, v109
    v_dot2c_f32_bf16 v157, v115, v109
    v_perm_b32 v114, v55, v51, s50
    v_perm_b32 v115, v55, v51, s51
    v_dot2c_f32_bf16 v158, v114, v109
    v_dot2c_f32_bf16 v159, v115, v109
    s_waitcnt vmcnt(4)
    v_perm_b32 v114, v60, v56, s50
    v_perm_b32 v115, v60, v56, s51
    s_waitcnt lgkmcnt(2)
    v_dot2c_f32_bf16 v152, v114, v110
    v_dot2c_f32_bf16 v153, v115, v110
    v_perm_b32 v114, v61, v57, s50
    v_perm_b32 v115, v61, v57, s51
    v_dot2c_f32_bf16 v154, v114, v110
    v_dot2c_f32_bf16 v155, v115, v110
    v_perm_b32 v114, v62, v58, s50
    v_perm_b32 v115, v62, v58, s51
    v_dot2c_f32_bf16 v156, v114, v110
    v_dot2c_f32_bf16 v157, v115, v110
    v_perm_b32 v114, v63, v59, s50
    v_perm_b32 v115, v63, v59, s51
    v_dot2c_f32_bf16 v158, v114, v110
    v_dot2c_f32_bf16 v159, v115, v110
    s_waitcnt vmcnt(2)
    v_perm_b32 v114, v68, v64, s50
    v_perm_b32 v115, v68, v64, s51
    s_waitcnt lgkmcnt(1)
    v_dot2c_f32_bf16 v152, v114, v111
    v_dot2c_f32_bf16 v153, v115, v111
    v_perm_b32 v114, v69, v65, s50
    v_perm_b32 v115, v69, v65, s51
    v_dot2c_f32_bf16 v154, v114, v111
    v_dot2c_f32_bf16 v155, v115, v111
    v_perm_b32 v114, v70, v66, s50
    v_perm_b32 v115, v70, v66, s51
    v_dot2c_f32_bf16 v156, v114, v111
    v_dot2c_f32_bf16 v157, v115, v111
    v_perm_b32 v114, v71, v67, s50
    v_perm_b32 v115, v71, v67, s51
    v_dot2c_f32_bf16 v158, v114, v111
    v_dot2c_f32_bf16 v159, v115, v111
    s_waitcnt vmcnt(0)
    v_perm_b32 v114, v76, v72, s50
    v_perm_b32 v115, v76, v72, s51
    s_waitcnt lgkmcnt(0)
    v_dot2c_f32_bf16 v152, v114, v112
    v_dot2c_f32_bf16 v153, v115, v112
    v_perm_b32 v114, v77, v73, s50
    v_perm_b32 v115, v77, v73, s51
    v_dot2c_f32_bf16 v154, v114, v112
    v_dot2c_f32_bf16 v155, v115, v112
    v_perm_b32 v114, v78, v74, s50
    v_perm_b32 v115, v78, v74, s51
    v_dot2c_f32_bf16 v156, v114, v112
    v_dot2c_f32_bf16 v157, v115, v112
    v_perm_b32 v114, v79, v75, s50
    v_perm_b32 v115, v79, v75, s51
    v_dot2c_f32_bf16 v158, v114, v112
    v_dot2c_f32_bf16 v159, v115, v112
    s_lshl_b32 s68, s68, 2
    s_add_u32 s68, s68, s69
    s_lshl_b32 s68, s68, 9
    s_add_u32 s68, s68, 0x1000
    v_permlane32_swap_b32 v152, v156
    v_permlane32_swap_b32 v153, v157
    v_permlane32_swap_b32 v154, v158
    v_permlane32_swap_b32 v155, v159
    v_add_f32 v152, v152, v156
    v_add_f32 v153, v153, v157
    v_add_f32 v154, v154, v158
    v_add_f32 v155, v155, v159
    s_nop 0
    v_permlane16_swap_b32 v152, v154
    v_permlane16_swap_b32 v153, v155
    v_add_f32 v152, v152, v154
    v_add_f32 v153, v153, v155
    s_nop 0
    v_add_f32_dpp v152, v152, v152 row_ror:8 row_mask:0xf bank_mask:0x3
    s_nop 1
    v_add_f32_dpp v152, v153, v153 row_ror:8 row_mask:0xf bank_mask:0xc
    v_mov_b32 v116, v152
    s_nop 0
    v_mov_b32_dpp v117, v152 row_ror:8 row_mask:0xf bank_mask:0xf
    v_mov_b32 v118, s48
    v_mov_b32 v119, s49
    v_and_b32 v120, 7, v1
    v_lshlrev_b32 v120, 6, v120
    v_lshrrev_b32 v121, 5, v1
    v_lshl_add_u32 v120, v121, 5, v120
    v_bfe_u32 v121, v1, 4, 1
    v_lshl_add_u32 v120, v121, 4, v120
    s_mov_b32 exec_lo, 0x00ff00ff
    s_mov_b32 exec_hi, 0x00ff00ff
    buffer_store_dwordx4 v[116:119], v120, s[44:47], s68 offen sc1
    s_mov_b64 exec, -1
    s_lshr_b32 s66, s2, 4
    s_lshl_b32 s66, s66, 13
    s_add_u32 s66, s66, 0x1000
    s_add_u32 s67, s66, 4096
    v_lshlrev_b32 v120, 4, v1
    s_mov_b32 s58, 0
L_x1_r_11:
    buffer_load_dwordx4 v[80:83], v120, s[44:47], s66 offen offset:0 sc1
    buffer_load_dwordx4 v[84:87], v120, s[44:47], s66 offen offset:1024 sc1
    buffer_load_dwordx4 v[88:91], v120, s[44:47], s66 offen offset:2048 sc1
    buffer_load_dwordx4 v[92:95], v120, s[44:47], s66 offen offset:3072 sc1
    buffer_load_dwordx4 v[96:99], v120, s[44:47], s67 offen offset:0 sc1
    buffer_load_dwordx4 v[100:103], v120, s[44:47], s67 offen offset:1024 sc1
    buffer_load_dwordx4 v[104:107], v120, s[44:47], s67 offen offset:2048 sc1
    buffer_load_dwordx4 v[108:111], v120, s[44:47], s67 offen offset:3072 sc1
    s_add_u32 s58, s58, 1
    s_waitcnt vmcnt(0)
    v_cmp_ne_u64 s[64:65], s[48:49], v[82:83]
    v_cmp_ne_u64 vcc, s[48:49], v[86:87]
    s_nop 1
    s_or_b64 s[64:65], s[64:65], vcc
    v_cmp_ne_u64 vcc, s[48:49], v[90:91]
    s_nop 1
    s_or_b64 s[64:65], s[64:65], vcc
    v_cmp_ne_u64 vcc, s[48:49], v[94:95]
    s_nop 1
    s_or_b64 s[64:65], s[64:65], vcc
    v_cmp_ne_u64 vcc, s[48:49], v[98:99]
    s_nop 1
    s_or_b64 s[64:65], s[64:65], vcc
    v_cmp_ne_u64 vcc, s[48:49], v[102:103]
    s_nop 1
    s_or_b64 s[64:65], s[64:65], vcc
    v_cmp_ne_u64 vcc, s[48:49], v[106:107]
    s_nop 1
    s_or_b64 s[64:65], s[64:65], vcc
    v_cmp_ne_u64 vcc, s[48:49], v[110:111]
    s_nop 1
    s_or_b64 s[64:65], s[64:65], vcc
    s_cmp_eq_u64 s[64:65], 0
    s_cbranch_scc1 L_x1_ok_12
    s_cmp_lt_u32 s58, 0x40000
    s_cbranch_scc1 L_x1_r_11
L_x1_ok_12:
    v_add_f32 v80, v80, v84
    v_add_f32 v81, v81, v85
    v_mov_b32 v121, v80
    s_nop 1
    v_permlane32_swap_b32 v80, v121
    v_add_f32 v80, v80, v121
    v_mov_b32 v122, v81
    s_nop 1
    v_permlane32_swap_b32 v81, v122
    v_add_f32 v81, v81, v122
    v_cvt_pk_bf16_f32 v80, v80, v81
    v_add_f32 v88, v88, v92
    v_add_f32 v89, v89, v93
    v_mov_b32 v121, v88
    s_nop 1
    v_permlane32_swap_b32 v88, v121
    v_add_f32 v88, v88, v121
    v_mov_b32 v122, v89
    s_nop 1
    v_permlane32_swap_b32 v89, v122
    v_add_f32 v89, v89, v122
    v_cvt_pk_bf16_f32 v88, v88, v89
    v_add_f32 v96, v96, v100
    v_add_f32 v97, v97, v101
    v_mov_b32 v121, v96
    s_nop 1
    v_permlane32_swap_b32 v96, v121
    v_add_f32 v96, v96, v121
    v_mov_b32 v122, v97
    s_nop 1
    v_permlane32_swap_b32 v97, v122
    v_add_f32 v97, v97, v122
    v_cvt_pk_bf16_f32 v96, v96, v97
    v_add_f32 v104, v104, v108
    v_add_f32 v105, v105, v109
    v_mov_b32 v121, v104
    s_nop 1
    v_permlane32_swap_b32 v104, v121
    v_add_f32 v104, v104, v121
    v_mov_b32 v122, v105
    s_nop 1
    v_permlane32_swap_b32 v105, v122
    v_add_f32 v105, v105, v122
    v_cvt_pk_bf16_f32 v104, v104, v105
    v_and_b32 v124, 31, v1
    v_lshlrev_b32 v124, 2, v124
    ds_write_b32 v124, v80 offset:256
    ds_write_b32 v124, v88 offset:384
    ds_write_b32 v124, v96 offset:512
    ds_write_b32 v124, v104 offset:640
    s_waitcnt lgkmcnt(0)
    v_mov_b32 v124, 0
    v_mov_b32 v125, 1
    ds_write_b32 v124, v125 offset:0
    s_mov_b32 s61, s2
    s_mul_i32 s78, s61, 7282
    s_lshr_b32 s78, s78, 16
    s_mul_i32 s79, s78, 9
    s_sub_u32 s79, s61, s79
    s_mul_i32 s80, s78, 147456
    s_lshl_b32 s82, s79, 7
    s_add_u32 s80, s80, s82
    v_lshrrev_b32 v163, 3, v1
    s_mov_b32 s63, 1152
    v_mul_lo_u32 v163, v163, s63
    v_and_b32 v164, 7, v1
    v_lshl_add_u32 v163, v164, 4, v163
    v_mov_b32 v165, 0
    s_mov_b32 s58, 0
L_lw_13:
    ds_read_b32 v164, v165 offset:24
    s_add_u32 s58, s58, 1
    s_waitcnt lgkmcnt(0)
    v_readfirstlane_b32 s62, v164
    s_nop 1
    s_cmp_ge_u32 s62, 3
    s_nop 0
    s_cbranch_scc1 L_lwd_14
    s_sleep 1
    s_cmp_lt_u32 s58, 0x400000
    s_cbranch_scc1 L_lw_13
L_lwd_14:
    buffer_load_dwordx4 v[8:11], v163, s[24:27], s80 offen nt
    s_add_u32 s80, s80, 9216
    buffer_load_dwordx4 v[12:15], v163, s[24:27], s80 offen nt
    s_add_u32 s80, s80, 9216
    buffer_load_dwordx4 v[16:19], v163, s[24:27], s80 offen nt
    s_add_u32 s80, s80, 9216
    buffer_load_dwordx4 v[20:23], v163, s[24:27], s80 offen nt
    s_add_u32 s80, s80, 9216
    buffer_load_dwordx4 v[24:27], v163, s[24:27], s80 offen nt
    s_add_u32 s80, s80, 9216
    buffer_load_dwordx4 v[28:31], v163, s[24:27], s80 offen nt
    s_add_u32 s80, s80, 9216
    buffer_load_dwordx4 v[32:35], v163, s[24:27], s80 offen nt
    s_add_u32 s80, s80, 9216
    buffer_load_dwordx4 v[36:39], v163, s[24:27], s80 offen nt
    s_add_u32 s80, s80, 9216
    buffer_load_dwordx4 v[40:43], v163, s[24:27], s80 offen nt
    s_add_u32 s80, s80, 9216
    buffer_load_dwordx4 v[44:47], v163, s[24:27], s80 offen nt
    s_add_u32 s80, s80, 9216
    buffer_load_dwordx4 v[48:51], v163, s[24:27], s80 offen nt
    s_add_u32 s80, s80, 9216
    buffer_load_dwordx4 v[52:55], v163, s[24:27], s80 offen nt
    s_add_u32 s80, s80, 9216
    buffer_load_dwordx4 v[56:59], v163, s[24:27], s80 offen nt
    s_add_u32 s80, s80, 9216
    buffer_load_dwordx4 v[60:63], v163, s[24:27], s80 offen nt
    s_add_u32 s80, s80, 9216
    buffer_load_dwordx4 v[64:67], v163, s[24:27], s80 offen nt
    s_add_u32 s80, s80, 9216
    buffer_load_dwordx4 v[68:71], v163, s[24:27], s80 offen nt
    v_mov_b32 v165, 0
    s_mov_b32 s58, 0
L_lw_15:
    ds_read_b32 v164, v165 offset:12
    s_add_u32 s58, s58, 1
    s_waitcnt lgkmcnt(0)
    v_readfirstlane_b32 s62, v164
    s_nop 1
    s_cmp_ge_u32 s62, 1
    s_nop 0
    s_cbranch_scc1 L_lwd_16
    s_sleep 1
    s_cmp_lt_u32 s58, 0x400000
    s_cbranch_scc1 L_lw_15
L_lwd_16:
    v_mov_b32 v166, 0
    ds_read_b64 v[164:165], v166 offset:16
    s_waitcnt lgkmcnt(0)
    v_readfirstlane_b32 s48, v164
    v_readfirstlane_b32 s49, v165
    s_waitcnt vmcnt(14)
    v_perm_b32 v148, v12, v8, s50
    v_perm_b32 v12, v12, v8, s51
    v_mov_b32 v8, v148
    v_perm_b32 v148, v13, v9, s50
    v_perm_b32 v13, v13, v9, s51
    v_mov_b32 v9, v148
    v_perm_b32 v148, v14, v10, s50
    v_perm_b32 v14, v14, v10, s51
    v_mov_b32 v10, v148
    v_perm_b32 v148, v15, v11, s50
    v_perm_b32 v15, v15, v11, s51
    v_mov_b32 v11, v148
    s_waitcnt vmcnt(12)
    v_perm_b32 v148, v20, v16, s50
    v_perm_b32 v20, v20, v16, s51
    v_mov_b32 v16, v148
    v_perm_b32 v148, v21, v17, s50
    v_perm_b32 v21, v21, v17, s51
    v_mov_b32 v17, v148
    v_perm_b32 v148, v22, v18, s50
    v_perm_b32 v22, v22, v18, s51
    v_mov_b32 v18, v148
    v_perm_b32 v148, v23, v19, s50
    v_perm_b32 v23, v23, v19, s51
    v_mov_b32 v19, v148
    s_waitcnt vmcnt(10)
    v_perm_b32 v148, v28, v24, s50
    v_perm_b32 v28, v28, v24, s51
    v_mov_b32 v24, v148
    v_perm_b32 v148, v29, v25, s50
    v_perm_b32 v29, v29, v25, s51
    v_mov_b32 v25, v148
    v_perm_b32 v148, v30, v26, s50
    v_perm_b32 v30, v30, v26, s51
    v_mov_b32 v26, v148
    v_perm_b32 v148, v31, v27, s50
    v_perm_b32 v31, v31, v27, s51
    v_mov_b32 v27, v148
    s_waitcnt vmcnt(8)
    v_perm_b32 v148, v36, v32, s50
    v_perm_b32 v36, v36, v32, s51
    v_mov_b32 v32, v148
    v_perm_b32 v148, v37, v33, s50
    v_perm_b32 v37, v37, v33, s51
    v_mov_b32 v33, v148
    v_perm_b32 v148, v38, v34, s50
    v_perm_b32 v38, v38, v34, s51
    v_mov_b32 v34, v148
    v_perm_b32 v148, v39, v35, s50
    v_perm_b32 v39, v39, v35, s51
    v_mov_b32 v35, v148
    s_waitcnt vmcnt(6)
    v_perm_b32 v148, v44, v40, s50
    v_perm_b32 v44, v44, v40, s51
    v_mov_b32 v40, v148
    v_perm_b32 v148, v45, v41, s50
    v_perm_b32 v45, v45, v41, s51
    v_mov_b32 v41, v148
    v_perm_b32 v148, v46, v42, s50
    v_perm_b32 v46, v46, v42, s51
    v_mov_b32 v42, v148
    v_perm_b32 v148, v47, v43, s50
    v_perm_b32 v47, v47, v43, s51
    v_mov_b32 v43, v148
    s_waitcnt vmcnt(4)
    v_perm_b32 v148, v52, v48, s50
    v_perm_b32 v52, v52, v48, s51
    v_mov_b32 v48, v148
    v_perm_b32 v148, v53, v49, s50
    v_perm_b32 v53, v53, v49, s51
    v_mov_b32 v49, v148
    v_perm_b32 v148, v54, v50, s50
    v_perm_b32 v54, v54, v50, s51
    v_mov_b32 v50, v148
    v_perm_b32 v148, v55, v51, s50
    v_perm_b32 v55, v55, v51, s51
    v_mov_b32 v51, v148
    s_waitcnt vmcnt(2)
    v_perm_b32 v148, v60, v56, s50
    v_perm_b32 v60, v60, v56, s51
    v_mov_b32 v56, v148
    v_perm_b32 v148, v61, v57, s50
    v_perm_b32 v61, v61, v57, s51
    v_mov_b32 v57, v148
    v_perm_b32 v148, v62, v58, s50
    v_perm_b32 v62, v62, v58, s51
    v_mov_b32 v58, v148
    v_perm_b32 v148, v63, v59, s50
    v_perm_b32 v63, v63, v59, s51
    v_mov_b32 v59, v148
    s_waitcnt vmcnt(0)
    v_perm_b32 v148, v68, v64, s50
    v_perm_b32 v68, v68, v64, s51
    v_mov_b32 v64, v148
    v_perm_b32 v148, v69, v65, s50
    v_perm_b32 v69, v69, v65, s51
    v_mov_b32 v65, v148
    v_perm_b32 v148, v70, v66, s50
    v_perm_b32 v70, v70, v66, s51
    v_mov_b32 v66, v148
    v_perm_b32 v148, v71, v67, s50
    v_perm_b32 v71, v71, v67, s51
    v_mov_b32 v67, v148
    v_mov_b32 v165, 0
    s_mov_b32 s58, 0
L_lw_17:
    ds_read_b32 v164, v165 offset:28
    s_add_u32 s58, s58, 1
    s_waitcnt lgkmcnt(0)
    v_readfirstlane_b32 s62, v164
    s_nop 1
    s_cmp_ge_u32 s62, 1
    s_nop 0
    s_cbranch_scc1 L_lwd_18
    s_sleep 1
    s_cmp_lt_u32 s58, 0x400000
    s_cbranch_scc1 L_lw_17
L_lwd_18:
    s_lshl_b32 s80, s78, 14
    s_add_u32 s80, s80, 0x100000
    s_add_u32 s91, s80, 4096
    s_add_u32 s92, s80, 8192
    s_add_u32 s93, s80, 12288
    s_lshl_b32 s82, s78, 8
    s_add_u32 s82, s82, 0x180000
    v_lshlrev_b32 v148, 4, v1
    v_and_b32 v149, 15, v1
    v_lshlrev_b32 v149, 4, v149
    s_mov_b32 s58, 0
L_x2_r_19:
    buffer_load_dwordx4 v[144:147], v149, s[44:47], s82 offen sc1
    buffer_load_dwordx4 v[80:83], v148, s[44:47], s80 offen offset:0 sc1
    buffer_load_dwordx4 v[84:87], v148, s[44:47], s80 offen offset:1024 sc1
    buffer_load_dwordx4 v[88:91], v148, s[44:47], s80 offen offset:2048 sc1
    buffer_load_dwordx4 v[92:95], v148, s[44:47], s80 offen offset:3072 sc1
    buffer_load_dwordx4 v[96:99], v148, s[44:47], s91 offen offset:0 sc1
    buffer_load_dwordx4 v[100:103], v148, s[44:47], s91 offen offset:1024 sc1
    buffer_load_dwordx4 v[104:107], v148, s[44:47], s91 offen offset:2048 sc1
    buffer_load_dwordx4 v[108:111], v148, s[44:47], s91 offen offset:3072 sc1
    buffer_load_dwordx4 v[112:115], v148, s[44:47], s92 offen offset:0 sc1
    buffer_load_dwordx4 v[116:119], v148, s[44:47], s92 offen offset:1024 sc1
    buffer_load_dwordx4 v[120:123], v148, s[44:47], s92 offen offset:2048 sc1
    buffer_load_dwordx4 v[124:127], v148, s[44:47], s92 offen offset:3072 sc1
    buffer_load_dwordx4 v[128:131], v148, s[44:47], s93 offen offset:0 sc1
    buffer_load_dwordx4 v[132:135], v148, s[44:47], s93 offen offset:1024 sc1
    buffer_load_dwordx4 v[136:139], v148, s[44:47], s93 offen offset:2048 sc1
    buffer_load_dwordx4 v[140:143], v148, s[44:47], s93 offen offset:3072 sc1
    s_add_u32 s58, s58, 1
    s_waitcnt vmcnt(0)
    v_cmp_ne_u64 s[64:65], s[48:49], v[146:147]
    v_cmp_ne_u64 vcc, s[48:49], v[82:83]
    s_nop 1
    s_or_b64 s[64:65], s[64:65], vcc
    v_cmp_ne_u64 vcc, s[48:49], v[86:87]
    s_nop 1
    s_or_b64 s[64:65], s[64:65], vcc
    v_cmp_ne_u64 vcc, s[48:49], v[90:91]
    s_nop 1
    s_or_b64 s[64:65], s[64:65], vcc
    v_cmp_ne_u64 vcc, s[48:49], v[94:95]
    s_nop 1
    s_or_b64 s[64:65], s[64:65], vcc
    v_cmp_ne_u64 vcc, s[48:49], v[98:99]
    s_nop 1
    s_or_b64 s[64:65], s[64:65], vcc
    v_cmp_ne_u64 vcc, s[48:49], v[102:103]
    s_nop 1
    s_or_b64 s[64:65], s[64:65], vcc
    v_cmp_ne_u64 vcc, s[48:49], v[106:107]
    s_nop 1
    s_or_b64 s[64:65], s[64:65], vcc
    v_cmp_ne_u64 vcc, s[48:49], v[110:111]
    s_nop 1
    s_or_b64 s[64:65], s[64:65], vcc
    v_cmp_ne_u64 vcc, s[48:49], v[114:115]
    s_nop 1
    s_or_b64 s[64:65], s[64:65], vcc
    v_cmp_ne_u64 vcc, s[48:49], v[118:119]
    s_nop 1
    s_or_b64 s[64:65], s[64:65], vcc
    v_cmp_ne_u64 vcc, s[48:49], v[122:123]
    s_nop 1
    s_or_b64 s[64:65], s[64:65], vcc
    v_cmp_ne_u64 vcc, s[48:49], v[126:127]
    s_nop 1
    s_or_b64 s[64:65], s[64:65], vcc
    v_cmp_ne_u64 vcc, s[48:49], v[130:131]
    s_nop 1
    s_or_b64 s[64:65], s[64:65], vcc
    v_cmp_ne_u64 vcc, s[48:49], v[134:135]
    s_nop 1
    s_or_b64 s[64:65], s[64:65], vcc
    v_cmp_ne_u64 vcc, s[48:49], v[138:139]
    s_nop 1
    s_or_b64 s[64:65], s[64:65], vcc
    v_cmp_ne_u64 vcc, s[48:49], v[142:143]
    s_nop 1
    s_or_b64 s[64:65], s[64:65], vcc
    s_cmp_eq_u64 s[64:65], 0
    s_cbranch_scc1 L_x2_ok_20
    s_cmp_lt_u32 s58, 0x40000
    s_cbranch_scc1 L_x2_r_19
L_x2_ok_20:
    v_max_f32_dpp v150, v144, v144 row_ror:1 row_mask:0xf bank_mask:0xf
    s_nop 1
    v_max_f32_dpp v150, v150, v150 row_ror:2 row_mask:0xf bank_mask:0xf
    s_nop 1
    v_max_f32_dpp v150, v150, v150 row_ror:4 row_mask:0xf bank_mask:0xf
    s_nop 1
    v_max_f32_dpp v150, v150, v150 row_ror:8 row_mask:0xf bank_mask:0xf
    v_sub_f32 v151, v144, v150
    v_mul_f32 v151, 0x3fb8aa3b, v151
    v_exp_f32 v151, v151
    s_nop 0
    v_mul_f32 v146, v151, v145
    s_nop 1
    v_add_f32_dpp v146, v146, v146 row_ror:1 row_mask:0xf bank_mask:0xf
    s_nop 1
    v_add_f32_dpp v146, v146, v146 row_ror:2 row_mask:0xf bank_mask:0xf
    s_nop 1
    v_add_f32_dpp v146, v146, v146 row_ror:4 row_mask:0xf bank_mask:0xf
    s_nop 1
    v_add_f32_dpp v146, v146, v146 row_ror:8 row_mask:0xf bank_mask:0xf
    v_rcp_f32 v146, v146
    s_nop 0
    v_mul_f32 v151, v151, v146
    s_nop 1
    v_mul_f32_dpp v144, v151, v80 row_newbcast:0 row_mask:0xf bank_mask:0xf
    v_mul_f32_dpp v145, v151, v81 row_newbcast:0 row_mask:0xf bank_mask:0xf
    s_nop 0
    v_fmac_f32_dpp v144, v151, v84 row_newbcast:1 row_mask:0xf bank_mask:0xf
    v_fmac_f32_dpp v145, v151, v85 row_newbcast:1 row_mask:0xf bank_mask:0xf
    s_nop 0
    v_fmac_f32_dpp v144, v151, v88 row_newbcast:2 row_mask:0xf bank_mask:0xf
    v_fmac_f32_dpp v145, v151, v89 row_newbcast:2 row_mask:0xf bank_mask:0xf
    s_nop 0
    v_fmac_f32_dpp v144, v151, v92 row_newbcast:3 row_mask:0xf bank_mask:0xf
    v_fmac_f32_dpp v145, v151, v93 row_newbcast:3 row_mask:0xf bank_mask:0xf
    s_nop 0
    v_fmac_f32_dpp v144, v151, v96 row_newbcast:4 row_mask:0xf bank_mask:0xf
    v_fmac_f32_dpp v145, v151, v97 row_newbcast:4 row_mask:0xf bank_mask:0xf
    s_nop 0
    v_fmac_f32_dpp v144, v151, v100 row_newbcast:5 row_mask:0xf bank_mask:0xf
    v_fmac_f32_dpp v145, v151, v101 row_newbcast:5 row_mask:0xf bank_mask:0xf
    s_nop 0
    v_fmac_f32_dpp v144, v151, v104 row_newbcast:6 row_mask:0xf bank_mask:0xf
    v_fmac_f32_dpp v145, v151, v105 row_newbcast:6 row_mask:0xf bank_mask:0xf
    s_nop 0
    v_fmac_f32_dpp v144, v151, v108 row_newbcast:7 row_mask:0xf bank_mask:0xf
    v_fmac_f32_dpp v145, v151, v109 row_newbcast:7 row_mask:0xf bank_mask:0xf
    s_nop 0
    v_fmac_f32_dpp v144, v151, v112 row_newbcast:8 row_mask:0xf bank_mask:0xf
    v_fmac_f32_dpp v145, v151, v113 row_newbcast:8 row_mask:0xf bank_mask:0xf
    s_nop 0
    v_fmac_f32_dpp v144, v151, v116 row_newbcast:9 row_mask:0xf bank_mask:0xf
    v_fmac_f32_dpp v145, v151, v117 row_newbcast:9 row_mask:0xf bank_mask:0xf
    s_nop 0
    v_fmac_f32_dpp v144, v151, v120 row_newbcast:10 row_mask:0xf bank_mask:0xf
    v_fmac_f32_dpp v145, v151, v121 row_newbcast:10 row_mask:0xf bank_mask:0xf
    s_nop 0
    v_fmac_f32_dpp v144, v151, v124 row_newbcast:11 row_mask:0xf bank_mask:0xf
    v_fmac_f32_dpp v145, v151, v125 row_newbcast:11 row_mask:0xf bank_mask:0xf
    s_nop 0
    v_fmac_f32_dpp v144, v151, v128 row_newbcast:12 row_mask:0xf bank_mask:0xf
    v_fmac_f32_dpp v145, v151, v129 row_newbcast:12 row_mask:0xf bank_mask:0xf
    s_nop 0
    v_fmac_f32_dpp v144, v151, v132 row_newbcast:13 row_mask:0xf bank_mask:0xf
    v_fmac_f32_dpp v145, v151, v133 row_newbcast:13 row_mask:0xf bank_mask:0xf
    s_nop 0
    v_fmac_f32_dpp v144, v151, v136 row_newbcast:14 row_mask:0xf bank_mask:0xf
    v_fmac_f32_dpp v145, v151, v137 row_newbcast:14 row_mask:0xf bank_mask:0xf
    s_nop 0
    v_fmac_f32_dpp v144, v151, v140 row_newbcast:15 row_mask:0xf bank_mask:0xf
    v_fmac_f32_dpp v145, v151, v141 row_newbcast:15 row_mask:0xf bank_mask:0xf
    v_cvt_pk_bf16_f32 v144, v144, v145
    v_lshrrev_b32 v150, 3, v1
    v_lshlrev_b32 v150, 5, v150
    v_and_b32 v151, 3, v1
    v_lshl_add_u32 v150, v151, 3, v150
    v_bfe_u32 v151, v1, 2, 1
    v_lshl_add_u32 v150, v151, 1, v150
    v_add_u32 v150, s60, v150
    ds_write_b16 v150, v144
    ds_write_b16_d16_hi v150, v144 offset:4
    v_lshrrev_b32 v150, 3, v1
    v_lshlrev_b32 v150, 2, v150
    v_add_u32 v150, s60, v150
    ds_read_b32 v80, v150 offset:0
    ds_read_b32 v81, v150 offset:32
    ds_read_b32 v82, v150 offset:64
    ds_read_b32 v83, v150 offset:96
    ds_read_b32 v84, v150 offset:128
    ds_read_b32 v85, v150 offset:160
    ds_read_b32 v86, v150 offset:192
    ds_read_b32 v87, v150 offset:224
    s_waitcnt lgkmcnt(7)
    v_dot2_f32_bf16 v152, v8, v80, 0
    v_dot2_f32_bf16 v153, v12, v80, 0
    v_dot2_f32_bf16 v154, v9, v80, 0
    v_dot2_f32_bf16 v155, v13, v80, 0
    v_dot2_f32_bf16 v156, v10, v80, 0
    v_dot2_f32_bf16 v157, v14, v80, 0
    v_dot2_f32_bf16 v158, v11, v80, 0
    v_dot2_f32_bf16 v159, v15, v80, 0
    s_waitcnt lgkmcnt(6)
    v_dot2c_f32_bf16 v152, v16, v81
    v_dot2c_f32_bf16 v153, v20, v81
    v_dot2c_f32_bf16 v154, v17, v81
    v_dot2c_f32_bf16 v155, v21, v81
    v_dot2c_f32_bf16 v156, v18, v81
    v_dot2c_f32_bf16 v157, v22, v81
    v_dot2c_f32_bf16 v158, v19, v81
    v_dot2c_f32_bf16 v159, v23, v81
    s_waitcnt lgkmcnt(5)
    v_dot2c_f32_bf16 v152, v24, v82
    v_dot2c_f32_bf16 v153, v28, v82
    v_dot2c_f32_bf16 v154, v25, v82
    v_dot2c_f32_bf16 v155, v29, v82
    v_dot2c_f32_bf16 v156, v26, v82
    v_dot2c_f32_bf16 v157, v30, v82
    v_dot2c_f32_bf16 v158, v27, v82
    v_dot2c_f32_bf16 v159, v31, v82
    s_waitcnt lgkmcnt(4)
    v_dot2c_f32_bf16 v152, v32, v83
    v_dot2c_f32_bf16 v153, v36, v83
    v_dot2c_f32_bf16 v154, v33, v83
    v_dot2c_f32_bf16 v155, v37, v83
    v_dot2c_f32_bf16 v156, v34, v83
    v_dot2c_f32_bf16 v157, v38, v83
    v_dot2c_f32_bf16 v158, v35, v83
    v_dot2c_f32_bf16 v159, v39, v83
    s_waitcnt lgkmcnt(3)
    v_dot2c_f32_bf16 v152, v40, v84
    v_dot2c_f32_bf16 v153, v44, v84
    v_dot2c_f32_bf16 v154, v41, v84
    v_dot2c_f32_bf16 v155, v45, v84
    v_dot2c_f32_bf16 v156, v42, v84
    v_dot2c_f32_bf16 v157, v46, v84
    v_dot2c_f32_bf16 v158, v43, v84
    v_dot2c_f32_bf16 v159, v47, v84
    s_waitcnt lgkmcnt(2)
    v_dot2c_f32_bf16 v152, v48, v85
    v_dot2c_f32_bf16 v153, v52, v85
    v_dot2c_f32_bf16 v154, v49, v85
    v_dot2c_f32_bf16 v155, v53, v85
    v_dot2c_f32_bf16 v156, v50, v85
    v_dot2c_f32_bf16 v157, v54, v85
    v_dot2c_f32_bf16 v158, v51, v85
    v_dot2c_f32_bf16 v159, v55, v85
    s_waitcnt lgkmcnt(1)
    v_dot2c_f32_bf16 v152, v56, v86
    v_dot2c_f32_bf16 v153, v60, v86
    v_dot2c_f32_bf16 v154, v57, v86
    v_dot2c_f32_bf16 v155, v61, v86
    v_dot2c_f32_bf16 v156, v58, v86
    v_dot2c_f32_bf16 v157, v62, v86
    v_dot2c_f32_bf16 v158, v59, v86
    v_dot2c_f32_bf16 v159, v63, v86
    s_waitcnt lgkmcnt(0)
    v_dot2c_f32_bf16 v152, v64, v87
    v_dot2c_f32_bf16 v153, v68, v87
    v_dot2c_f32_bf16 v154, v65, v87
    v_dot2c_f32_bf16 v155, v69, v87
    v_dot2c_f32_bf16 v156, v66, v87
    v_dot2c_f32_bf16 v157, v70, v87
    v_dot2c_f32_bf16 v158, v67, v87
    v_dot2c_f32_bf16 v159, v71, v87
    s_lshl_b32 s82, s79, 5
    s_add_u32 s82, s82, s78
    s_lshl_b32 s82, s82, 9
    s_add_u32 s82, s82, 0x190000
    v_permlane32_swap_b32 v152, v156
    v_permlane32_swap_b32 v153, v157
    v_permlane32_swap_b32 v154, v158
    v_permlane32_swap_b32 v155, v159
    v_add_f32 v152, v152, v156
    v_add_f32 v153, v153, v157
    v_add_f32 v154, v154, v158
    v_add_f32 v155, v155, v159
    s_nop 0
    v_permlane16_swap_b32 v152, v154
    v_permlane16_swap_b32 v153, v155
    v_add_f32 v152, v152, v154
    v_add_f32 v153, v153, v155
    s_nop 0
    v_add_f32_dpp v152, v152, v152 row_ror:8 row_mask:0xf bank_mask:0x3
    s_nop 1
    v_add_f32_dpp v152, v153, v153 row_ror:8 row_mask:0xf bank_mask:0xc
    v_mov_b32 v88, v152
    s_nop 0
    v_mov_b32_dpp v89, v152 row_ror:8 row_mask:0xf bank_mask:0xf
    v_mov_b32 v90, s48
    v_mov_b32 v91, s49
    v_and_b32 v92, 7, v1
    v_lshlrev_b32 v92, 6, v92
    v_lshrrev_b32 v93, 5, v1
    v_lshl_add_u32 v92, v93, 5, v92
    v_bfe_u32 v93, v1, 4, 1
    v_lshl_add_u32 v92, v93, 4, v92
    s_mov_b32 exec_lo, 0x00ff00ff
    s_mov_b32 exec_hi, 0x00ff00ff
    buffer_store_dwordx4 v[88:91], v92, s[44:47], s82 offen sc1
    s_mov_b64 exec, -1
    s_branch L_exit_recurrent_scan__sliding_block_cached__swiglu_ffn__decode_kernel
L_t1_8:
    s_mul_i32 s60, s3, 2560
    s_add_u32 s60, s60, 12288
    v_lshlrev_b32 v125, 2, v1
    buffer_load_dword v120, v125, s[8:11], 0 offen offset:0
    buffer_load_dword v121, v125, s[8:11], 0 offen offset:256
    buffer_load_dword v122, v125, s[8:11], 0 offen offset:512
    buffer_load_dword v123, v125, s[8:11], 0 offen offset:768
    buffer_load_dword v124, v125, s[8:11], 0 offen offset:1024
    s_waitcnt vmcnt(4)
    v_lshlrev_b32 v80, 16, v120
    v_and_b32 v81, 0xffff0000, v120
    s_waitcnt vmcnt(3)
    v_lshlrev_b32 v82, 16, v121
    v_and_b32 v83, 0xffff0000, v121
    s_waitcnt vmcnt(2)
    v_lshlrev_b32 v84, 16, v122
    v_and_b32 v85, 0xffff0000, v122
    s_waitcnt vmcnt(1)
    v_lshlrev_b32 v86, 16, v123
    v_and_b32 v87, 0xffff0000, v123
    s_waitcnt vmcnt(0)
    v_lshlrev_b32 v88, 16, v124
    v_and_b32 v89, 0xffff0000, v124
    v_add_f32 v90, v80, v81
    v_add_f32 v90, v90, v82
    v_add_f32 v90, v90, v83
    v_add_f32 v90, v90, v84
    v_add_f32 v90, v90, v85
    v_add_f32 v90, v90, v86
    v_add_f32 v90, v90, v87
    v_add_f32 v90, v90, v88
    v_add_f32 v90, v90, v89
    s_nop 1
    v_add_f32_dpp v90, v90, v90 quad_perm:[1,0,3,2] row_mask:0xf bank_mask:0xf
    s_nop 1
    v_add_f32_dpp v90, v90, v90 quad_perm:[2,3,0,1] row_mask:0xf bank_mask:0xf
    s_nop 1
    v_add_f32_dpp v90, v90, v90 row_half_mirror row_mask:0xf bank_mask:0xf
    s_nop 1
    v_add_f32_dpp v90, v90, v90 row_mirror row_mask:0xf bank_mask:0xf
    v_mov_b32 v91, v90
    s_nop 1
    v_permlane16_swap_b32 v90, v91
    v_add_f32 v90, v90, v91
    v_mov_b32 v91, v90
    s_nop 1
    v_permlane32_swap_b32 v90, v91
    v_add_f32 v90, v90, v91
    v_mul_f32 v92, 0x3ae38e39, v90
    v_mov_b32 v93, 0
    v_sub_f32 v94, v80, v92
    v_fmac_f32 v93, v94, v94
    v_sub_f32 v94, v81, v92
    v_fmac_f32 v93, v94, v94
    v_sub_f32 v94, v82, v92
    v_fmac_f32 v93, v94, v94
    v_sub_f32 v94, v83, v92
    v_fmac_f32 v93, v94, v94
    v_sub_f32 v94, v84, v92
    v_fmac_f32 v93, v94, v94
    v_sub_f32 v94, v85, v92
    v_fmac_f32 v93, v94, v94
    v_sub_f32 v94, v86, v92
    v_fmac_f32 v93, v94, v94
    v_sub_f32 v94, v87, v92
    v_fmac_f32 v93, v94, v94
    v_sub_f32 v94, v88, v92
    v_cndmask_b32 v94, 0, v94, s[56:57]
    v_fmac_f32 v93, v94, v94
    v_sub_f32 v94, v89, v92
    v_cndmask_b32 v94, 0, v94, s[56:57]
    v_fmac_f32 v93, v94, v94
    s_nop 1
    v_add_f32_dpp v93, v93, v93 quad_perm:[1,0,3,2] row_mask:0xf bank_mask:0xf
    s_nop 1
    v_add_f32_dpp v93, v93, v93 quad_perm:[2,3,0,1] row_mask:0xf bank_mask:0xf
    s_nop 1
    v_add_f32_dpp v93, v93, v93 row_half_mirror row_mask:0xf bank_mask:0xf
    s_nop 1
    v_add_f32_dpp v93, v93, v93 row_mirror row_mask:0xf bank_mask:0xf
    v_mov_b32 v91, v93
    s_nop 1
    v_permlane16_swap_b32 v93, v91
    v_add_f32 v93, v93, v91
    v_mov_b32 v91, v93
    s_nop 1
    v_permlane32_swap_b32 v93, v91
    v_add_f32 v93, v93, v91
    v_mul_f32 v93, 0x3ae38e39, v93
    v_cvt_pk_bf16_f32 v95, v92, v92
    v_lshlrev_b32 v95, 16, v95
    v_cvt_pk_bf16_f32 v96, v93, v93
    v_lshlrev_b32 v96, 16, v96
    v_add_f32 v96, 0x3727c5ac, v96
    v_cvt_pk_bf16_f32 v96, v96, v96
    v_lshlrev_b32 v96, 16, v96
    v_sqrt_f32 v96, v96
    s_nop 0
    v_cvt_pk_bf16_f32 v96, v96, v96
    v_lshlrev_b32 v96, 16, v96
    v_rcp_f32 v97, v96
    v_lshrrev_b32 v98, 3, v1
    v_lshlrev_b32 v98, 5, v98
    v_and_b32 v99, 3, v1
    v_lshl_add_u32 v98, v99, 3, v98
    v_bfe_u32 v99, v1, 2, 1
    v_lshl_add_u32 v98, v99, 1, v98
    v_add_u32 v98, s60, v98
    v_sub_f32 v80, v80, v95
    v_sub_f32 v81, v81, v95
    v_cvt_pk_bf16_f32 v91, v80, v81
    v_lshlrev_b32 v80, 16, v91
    v_and_b32 v81, 0xffff0000, v91
    v_mul_f32 v100, v80, v97
    v_fma_f32 v101, -v100, v96, v80
    v_fma_f32 v80, v101, v97, v100
    v_mul_f32 v100, v81, v97
    v_fma_f32 v101, -v100, v96, v81
    v_fma_f32 v81, v101, v97, v100
    v_cvt_pk_bf16_f32 v91, v80, v81
    ds_write_b16 v98, v91 offset:0
    ds_write_b16_d16_hi v98, v91 offset:4
    v_sub_f32 v82, v82, v95
    v_sub_f32 v83, v83, v95
    v_cvt_pk_bf16_f32 v91, v82, v83
    v_lshlrev_b32 v82, 16, v91
    v_and_b32 v83, 0xffff0000, v91
    v_mul_f32 v100, v82, v97
    v_fma_f32 v101, -v100, v96, v82
    v_fma_f32 v82, v101, v97, v100
    v_mul_f32 v100, v83, v97
    v_fma_f32 v101, -v100, v96, v83
    v_fma_f32 v83, v101, v97, v100
    v_cvt_pk_bf16_f32 v91, v82, v83
    ds_write_b16 v98, v91 offset:256
    ds_write_b16_d16_hi v98, v91 offset:260
    v_sub_f32 v84, v84, v95
    v_sub_f32 v85, v85, v95
    v_cvt_pk_bf16_f32 v91, v84, v85
    v_lshlrev_b32 v84, 16, v91
    v_and_b32 v85, 0xffff0000, v91
    v_mul_f32 v100, v84, v97
    v_fma_f32 v101, -v100, v96, v84
    v_fma_f32 v84, v101, v97, v100
    v_mul_f32 v100, v85, v97
    v_fma_f32 v101, -v100, v96, v85
    v_fma_f32 v85, v101, v97, v100
    v_cvt_pk_bf16_f32 v91, v84, v85
    ds_write_b16 v98, v91 offset:512
    ds_write_b16_d16_hi v98, v91 offset:516
    v_sub_f32 v86, v86, v95
    v_sub_f32 v87, v87, v95
    v_cvt_pk_bf16_f32 v91, v86, v87
    v_lshlrev_b32 v86, 16, v91
    v_and_b32 v87, 0xffff0000, v91
    v_mul_f32 v100, v86, v97
    v_fma_f32 v101, -v100, v96, v86
    v_fma_f32 v86, v101, v97, v100
    v_mul_f32 v100, v87, v97
    v_fma_f32 v101, -v100, v96, v87
    v_fma_f32 v87, v101, v97, v100
    v_cvt_pk_bf16_f32 v91, v86, v87
    ds_write_b16 v98, v91 offset:768
    ds_write_b16_d16_hi v98, v91 offset:772
    v_sub_f32 v88, v88, v95
    v_sub_f32 v89, v89, v95
    v_cvt_pk_bf16_f32 v91, v88, v89
    v_lshlrev_b32 v88, 16, v91
    v_and_b32 v89, 0xffff0000, v91
    v_mul_f32 v100, v88, v97
    v_fma_f32 v101, -v100, v96, v88
    v_fma_f32 v88, v101, v97, v100
    v_mul_f32 v100, v89, v97
    v_fma_f32 v101, -v100, v96, v89
    v_fma_f32 v89, v101, v97, v100
    v_cvt_pk_bf16_f32 v91, v88, v89
    ds_write_b16 v98, v91 offset:1024
    ds_write_b16_d16_hi v98, v91 offset:1028
    s_cmp_lg_u32 s3, 9
    s_cbranch_scc1 L_t2_9
    s_lshl_b32 s61, s2, 1
    s_and_b32 s72, s61, 3
    s_lshr_b32 s73, s61, 4
    s_bfe_u32 s74, s61, 0x10002
    s_lshl_b32 s70, s73, 1
    s_add_u32 s70, s70, s74
    s_lshl_b32 s70, s70, 7
    s_mul_i32 s75, s72, 1327104
    s_add_u32 s70, s70, s75
    s_mul_i32 s75, s72, 288
    s_add_u32 s75, s75, s60
    v_lshrrev_b32 v161, 3, v1
    v_lshlrev_b32 v161, 2, v161
    v_add_u32 v161, s75, v161
    ds_read_b32 v152, v161 offset:0
    ds_read_b32 v153, v161 offset:32
    ds_read_b32 v154, v161 offset:64
    ds_read_b32 v155, v161 offset:96
    ds_read_b32 v156, v161 offset:128
    ds_read_b32 v157, v161 offset:160
    ds_read_b32 v158, v161 offset:192
    ds_read_b32 v159, v161 offset:224
    ds_read_b32 v160, v161 offset:256
    v_mov_b32 v165, 0
    s_mov_b32 s58, 0
L_lw_21:
    ds_read_b32 v164, v165 offset:4
    s_add_u32 s58, s58, 1
    s_waitcnt lgkmcnt(0)
    v_readfirstlane_b32 s62, v164
    s_nop 1
    s_cmp_ge_u32 s62, 8
    s_nop 0
    s_cbranch_scc1 L_lwd_22
    s_sleep 1
    s_cmp_lt_u32 s58, 0x400000
    s_cbranch_scc1 L_lw_21
L_lwd_22:
    v_lshrrev_b32 v163, 3, v1
    s_mov_b32 s63, 9216
    v_mul_lo_u32 v163, v163, s63
    v_and_b32 v164, 7, v1
    v_lshl_add_u32 v163, v164, 4, v163
    s_bitcmp1_b32 s61, 3
    s_cbranch_scc1 L_gup_23
    buffer_load_dwordx4 v[8:11], v163, s[28:31], s70 offen nt
    s_add_u32 s70, s70, 73728
    buffer_load_dwordx4 v[12:15], v163, s[28:31], s70 offen nt
    s_add_u32 s70, s70, 73728
    buffer_load_dwordx4 v[16:19], v163, s[28:31], s70 offen nt
    s_add_u32 s70, s70, 73728
    buffer_load_dwordx4 v[20:23], v163, s[28:31], s70 offen nt
    s_add_u32 s70, s70, 73728
    buffer_load_dwordx4 v[24:27], v163, s[28:31], s70 offen nt
    s_add_u32 s70, s70, 73728
    buffer_load_dwordx4 v[28:31], v163, s[28:31], s70 offen nt
    s_add_u32 s70, s70, 73728
    buffer_load_dwordx4 v[32:35], v163, s[28:31], s70 offen nt
    s_add_u32 s70, s70, 73728
    buffer_load_dwordx4 v[36:39], v163, s[28:31], s70 offen nt
    s_add_u32 s70, s70, 73728
    buffer_load_dwordx4 v[40:43], v163, s[28:31], s70 offen nt
    s_add_u32 s70, s70, 73728
    buffer_load_dwordx4 v[44:47], v163, s[28:31], s70 offen nt
    s_add_u32 s70, s70, 73728
    buffer_load_dwordx4 v[48:51], v163, s[28:31], s70 offen nt
    s_add_u32 s70, s70, 73728
    buffer_load_dwordx4 v[52:55], v163, s[28:31], s70 offen nt
    s_add_u32 s70, s70, 73728
    buffer_load_dwordx4 v[56:59], v163, s[28:31], s70 offen nt
    s_add_u32 s70, s70, 73728
    buffer_load_dwordx4 v[60:63], v163, s[28:31], s70 offen nt
    s_add_u32 s70, s70, 73728
    buffer_load_dwordx4 v[64:67], v163, s[28:31], s70 offen nt
    s_add_u32 s70, s70, 73728
    buffer_load_dwordx4 v[68:71], v163, s[28:31], s70 offen nt
    s_add_u32 s70, s70, 73728
    buffer_load_dwordx4 v[72:75], v163, s[28:31], s70 offen nt
    s_add_u32 s70, s70, 73728
    buffer_load_dwordx4 v[76:79], v163, s[28:31], s70 offen nt
    s_branch L_gdn_24
L_gup_23:
    buffer_load_dwordx4 v[8:11], v163, s[32:35], s70 offen nt
    s_add_u32 s70, s70, 73728
    buffer_load_dwordx4 v[12:15], v163, s[32:35], s70 offen nt
    s_add_u32 s70, s70, 73728
    buffer_load_dwordx4 v[16:19], v163, s[32:35], s70 offen nt
    s_add_u32 s70, s70, 73728
    buffer_load_dwordx4 v[20:23], v163, s[32:35], s70 offen nt
    s_add_u32 s70, s70, 73728
    buffer_load_dwordx4 v[24:27], v163, s[32:35], s70 offen nt
    s_add_u32 s70, s70, 73728
    buffer_load_dwordx4 v[28:31], v163, s[32:35], s70 offen nt
    s_add_u32 s70, s70, 73728
    buffer_load_dwordx4 v[32:35], v163, s[32:35], s70 offen nt
    s_add_u32 s70, s70, 73728
    buffer_load_dwordx4 v[36:39], v163, s[32:35], s70 offen nt
    s_add_u32 s70, s70, 73728
    buffer_load_dwordx4 v[40:43], v163, s[32:35], s70 offen nt
    s_add_u32 s70, s70, 73728
    buffer_load_dwordx4 v[44:47], v163, s[32:35], s70 offen nt
    s_add_u32 s70, s70, 73728
    buffer_load_dwordx4 v[48:51], v163, s[32:35], s70 offen nt
    s_add_u32 s70, s70, 73728
    buffer_load_dwordx4 v[52:55], v163, s[32:35], s70 offen nt
    s_add_u32 s70, s70, 73728
    buffer_load_dwordx4 v[56:59], v163, s[32:35], s70 offen nt
    s_add_u32 s70, s70, 73728
    buffer_load_dwordx4 v[60:63], v163, s[32:35], s70 offen nt
    s_add_u32 s70, s70, 73728
    buffer_load_dwordx4 v[64:67], v163, s[32:35], s70 offen nt
    s_add_u32 s70, s70, 73728
    buffer_load_dwordx4 v[68:71], v163, s[32:35], s70 offen nt
    s_add_u32 s70, s70, 73728
    buffer_load_dwordx4 v[72:75], v163, s[32:35], s70 offen nt
    s_add_u32 s70, s70, 73728
    buffer_load_dwordx4 v[76:79], v163, s[32:35], s70 offen nt
L_gdn_24:
    v_mov_b32 v164, 0
    v_mov_b32 v165, 1
    s_mov_b64 exec, 1
    ds_add_u32 v164, v165 offset:24
    s_mov_b64 exec, -1
    s_waitcnt vmcnt(16)
    v_perm_b32 v161, v12, v8, s50
    v_perm_b32 v162, v12, v8, s51
    v_dot2_f32_bf16 v144, v161, v152, 0
    v_dot2_f32_bf16 v145, v162, v152, 0
    v_perm_b32 v161, v13, v9, s50
    v_perm_b32 v162, v13, v9, s51
    v_dot2_f32_bf16 v146, v161, v152, 0
    v_dot2_f32_bf16 v147, v162, v152, 0
    v_perm_b32 v161, v14, v10, s50
    v_perm_b32 v162, v14, v10, s51
    v_dot2_f32_bf16 v148, v161, v152, 0
    v_dot2_f32_bf16 v149, v162, v152, 0
    v_perm_b32 v161, v15, v11, s50
    v_perm_b32 v162, v15, v11, s51
    v_dot2_f32_bf16 v150, v161, v152, 0
    v_dot2_f32_bf16 v151, v162, v152, 0
    s_waitcnt vmcnt(14)
    v_perm_b32 v161, v20, v16, s50
    v_perm_b32 v162, v20, v16, s51
    v_dot2c_f32_bf16 v144, v161, v153
    v_dot2c_f32_bf16 v145, v162, v153
    v_perm_b32 v161, v21, v17, s50
    v_perm_b32 v162, v21, v17, s51
    v_dot2c_f32_bf16 v146, v161, v153
    v_dot2c_f32_bf16 v147, v162, v153
    v_perm_b32 v161, v22, v18, s50
    v_perm_b32 v162, v22, v18, s51
    v_dot2c_f32_bf16 v148, v161, v153
    v_dot2c_f32_bf16 v149, v162, v153
    v_perm_b32 v161, v23, v19, s50
    v_perm_b32 v162, v23, v19, s51
    v_dot2c_f32_bf16 v150, v161, v153
    v_dot2c_f32_bf16 v151, v162, v153
    s_waitcnt vmcnt(12)
    v_perm_b32 v161, v28, v24, s50
    v_perm_b32 v162, v28, v24, s51
    v_dot2c_f32_bf16 v144, v161, v154
    v_dot2c_f32_bf16 v145, v162, v154
    v_perm_b32 v161, v29, v25, s50
    v_perm_b32 v162, v29, v25, s51
    v_dot2c_f32_bf16 v146, v161, v154
    v_dot2c_f32_bf16 v147, v162, v154
    v_perm_b32 v161, v30, v26, s50
    v_perm_b32 v162, v30, v26, s51
    v_dot2c_f32_bf16 v148, v161, v154
    v_dot2c_f32_bf16 v149, v162, v154
    v_perm_b32 v161, v31, v27, s50
    v_perm_b32 v162, v31, v27, s51
    v_dot2c_f32_bf16 v150, v161, v154
    v_dot2c_f32_bf16 v151, v162, v154
    s_waitcnt vmcnt(10)
    v_perm_b32 v161, v36, v32, s50
    v_perm_b32 v162, v36, v32, s51
    v_dot2c_f32_bf16 v144, v161, v155
    v_dot2c_f32_bf16 v145, v162, v155
    v_perm_b32 v161, v37, v33, s50
    v_perm_b32 v162, v37, v33, s51
    v_dot2c_f32_bf16 v146, v161, v155
    v_dot2c_f32_bf16 v147, v162, v155
    v_perm_b32 v161, v38, v34, s50
    v_perm_b32 v162, v38, v34, s51
    v_dot2c_f32_bf16 v148, v161, v155
    v_dot2c_f32_bf16 v149, v162, v155
    v_perm_b32 v161, v39, v35, s50
    v_perm_b32 v162, v39, v35, s51
    v_dot2c_f32_bf16 v150, v161, v155
    v_dot2c_f32_bf16 v151, v162, v155
    s_waitcnt vmcnt(8)
    v_perm_b32 v161, v44, v40, s50
    v_perm_b32 v162, v44, v40, s51
    v_dot2c_f32_bf16 v144, v161, v156
    v_dot2c_f32_bf16 v145, v162, v156
    v_perm_b32 v161, v45, v41, s50
    v_perm_b32 v162, v45, v41, s51
    v_dot2c_f32_bf16 v146, v161, v156
    v_dot2c_f32_bf16 v147, v162, v156
    v_perm_b32 v161, v46, v42, s50
    v_perm_b32 v162, v46, v42, s51
    v_dot2c_f32_bf16 v148, v161, v156
    v_dot2c_f32_bf16 v149, v162, v156
    v_perm_b32 v161, v47, v43, s50
    v_perm_b32 v162, v47, v43, s51
    v_dot2c_f32_bf16 v150, v161, v156
    v_dot2c_f32_bf16 v151, v162, v156
    s_waitcnt vmcnt(6)
    v_perm_b32 v161, v52, v48, s50
    v_perm_b32 v162, v52, v48, s51
    v_dot2c_f32_bf16 v144, v161, v157
    v_dot2c_f32_bf16 v145, v162, v157
    v_perm_b32 v161, v53, v49, s50
    v_perm_b32 v162, v53, v49, s51
    v_dot2c_f32_bf16 v146, v161, v157
    v_dot2c_f32_bf16 v147, v162, v157
    v_perm_b32 v161, v54, v50, s50
    v_perm_b32 v162, v54, v50, s51
    v_dot2c_f32_bf16 v148, v161, v157
    v_dot2c_f32_bf16 v149, v162, v157
    v_perm_b32 v161, v55, v51, s50
    v_perm_b32 v162, v55, v51, s51
    v_dot2c_f32_bf16 v150, v161, v157
    v_dot2c_f32_bf16 v151, v162, v157
    s_waitcnt vmcnt(4)
    v_perm_b32 v161, v60, v56, s50
    v_perm_b32 v162, v60, v56, s51
    v_dot2c_f32_bf16 v144, v161, v158
    v_dot2c_f32_bf16 v145, v162, v158
    v_perm_b32 v161, v61, v57, s50
    v_perm_b32 v162, v61, v57, s51
    v_dot2c_f32_bf16 v146, v161, v158
    v_dot2c_f32_bf16 v147, v162, v158
    v_perm_b32 v161, v62, v58, s50
    v_perm_b32 v162, v62, v58, s51
    v_dot2c_f32_bf16 v148, v161, v158
    v_dot2c_f32_bf16 v149, v162, v158
    v_perm_b32 v161, v63, v59, s50
    v_perm_b32 v162, v63, v59, s51
    v_dot2c_f32_bf16 v150, v161, v158
    v_dot2c_f32_bf16 v151, v162, v158
    s_waitcnt vmcnt(2)
    v_perm_b32 v161, v68, v64, s50
    v_perm_b32 v162, v68, v64, s51
    v_dot2c_f32_bf16 v144, v161, v159
    v_dot2c_f32_bf16 v145, v162, v159
    v_perm_b32 v161, v69, v65, s50
    v_perm_b32 v162, v69, v65, s51
    v_dot2c_f32_bf16 v146, v161, v159
    v_dot2c_f32_bf16 v147, v162, v159
    v_perm_b32 v161, v70, v66, s50
    v_perm_b32 v162, v70, v66, s51
    v_dot2c_f32_bf16 v148, v161, v159
    v_dot2c_f32_bf16 v149, v162, v159
    v_perm_b32 v161, v71, v67, s50
    v_perm_b32 v162, v71, v67, s51
    v_dot2c_f32_bf16 v150, v161, v159
    v_dot2c_f32_bf16 v151, v162, v159
    s_waitcnt vmcnt(0)
    v_perm_b32 v161, v76, v72, s50
    v_perm_b32 v162, v76, v72, s51
    v_dot2c_f32_bf16 v144, v161, v160
    v_dot2c_f32_bf16 v145, v162, v160
    v_perm_b32 v161, v77, v73, s50
    v_perm_b32 v162, v77, v73, s51
    v_dot2c_f32_bf16 v146, v161, v160
    v_dot2c_f32_bf16 v147, v162, v160
    v_perm_b32 v161, v78, v74, s50
    v_perm_b32 v162, v78, v74, s51
    v_dot2c_f32_bf16 v148, v161, v160
    v_dot2c_f32_bf16 v149, v162, v160
    v_perm_b32 v161, v79, v75, s50
    v_perm_b32 v162, v79, v75, s51
    v_dot2c_f32_bf16 v150, v161, v160
    v_dot2c_f32_bf16 v151, v162, v160
    s_lshl_b32 s71, s61, 9
    s_add_u32 s71, s71, 0x40000
    v_mov_b32 v165, 0
    s_mov_b32 s58, 0
L_lw_25:
    ds_read_b32 v164, v165 offset:12
    s_add_u32 s58, s58, 1
    s_waitcnt lgkmcnt(0)
    v_readfirstlane_b32 s62, v164
    s_nop 1
    s_cmp_ge_u32 s62, 1
    s_nop 0
    s_cbranch_scc1 L_lwd_26
    s_sleep 1
    s_cmp_lt_u32 s58, 0x400000
    s_cbranch_scc1 L_lw_25
L_lwd_26:
    v_mov_b32 v166, 0
    ds_read_b64 v[164:165], v166 offset:16
    s_waitcnt lgkmcnt(0)
    v_readfirstlane_b32 s48, v164
    v_readfirstlane_b32 s49, v165
    v_permlane32_swap_b32 v144, v148
    v_permlane32_swap_b32 v145, v149
    v_permlane32_swap_b32 v146, v150
    v_permlane32_swap_b32 v147, v151
    v_add_f32 v144, v144, v148
    v_add_f32 v145, v145, v149
    v_add_f32 v146, v146, v150
    v_add_f32 v147, v147, v151
    s_nop 0
    v_permlane16_swap_b32 v144, v146
    v_permlane16_swap_b32 v145, v147
    v_add_f32 v144, v144, v146
    v_add_f32 v145, v145, v147
    s_nop 0
    v_add_f32_dpp v144, v144, v144 row_ror:8 row_mask:0xf bank_mask:0x3
    s_nop 1
    v_add_f32_dpp v144, v145, v145 row_ror:8 row_mask:0xf bank_mask:0xc
    v_mov_b32 v8, v144
    s_nop 0
    v_mov_b32_dpp v9, v144 row_ror:8 row_mask:0xf bank_mask:0xf
    v_mov_b32 v10, s48
    v_mov_b32 v11, s49
    v_and_b32 v12, 7, v1
    v_lshlrev_b32 v12, 6, v12
    v_lshrrev_b32 v13, 5, v1
    v_lshl_add_u32 v12, v13, 5, v12
    v_bfe_u32 v13, v1, 4, 1
    v_lshl_add_u32 v12, v13, 4, v12
    s_mov_b32 exec_lo, 0x00ff00ff
    s_mov_b32 exec_hi, 0x00ff00ff
    buffer_store_dwordx4 v[8:11], v12, s[44:47], s71 offen sc1
    s_mov_b64 exec, -1
    s_mov_b32 s61, s2
    s_mul_i32 s78, s61, 7282
    s_lshr_b32 s78, s78, 16
    s_mul_i32 s79, s78, 9
    s_sub_u32 s79, s61, s79
    s_mul_i32 s80, s78, 147456
    s_lshl_b32 s82, s79, 7
    s_add_u32 s80, s80, s82
    v_lshrrev_b32 v163, 3, v1
    s_mov_b32 s63, 1152
    v_mul_lo_u32 v163, v163, s63
    v_and_b32 v164, 7, v1
    v_lshl_add_u32 v163, v164, 4, v163
    v_mov_b32 v165, 0
    s_mov_b32 s58, 0
L_lw_27:
    ds_read_b32 v164, v165 offset:24
    s_add_u32 s58, s58, 1
    s_waitcnt lgkmcnt(0)
    v_readfirstlane_b32 s62, v164
    s_nop 1
    s_cmp_ge_u32 s62, 3
    s_nop 0
    s_cbranch_scc1 L_lwd_28
    s_sleep 1
    s_cmp_lt_u32 s58, 0x400000
    s_cbranch_scc1 L_lw_27
L_lwd_28:
    buffer_load_dwordx4 v[8:11], v163, s[36:39], s80 offen nt
    s_add_u32 s80, s80, 9216
    buffer_load_dwordx4 v[12:15], v163, s[36:39], s80 offen nt
    s_add_u32 s80, s80, 9216
    buffer_load_dwordx4 v[16:19], v163, s[36:39], s80 offen nt
    s_add_u32 s80, s80, 9216
    buffer_load_dwordx4 v[20:23], v163, s[36:39], s80 offen nt
    s_add_u32 s80, s80, 9216
    buffer_load_dwordx4 v[24:27], v163, s[36:39], s80 offen nt
    s_add_u32 s80, s80, 9216
    buffer_load_dwordx4 v[28:31], v163, s[36:39], s80 offen nt
    s_add_u32 s80, s80, 9216
    buffer_load_dwordx4 v[32:35], v163, s[36:39], s80 offen nt
    s_add_u32 s80, s80, 9216
    buffer_load_dwordx4 v[36:39], v163, s[36:39], s80 offen nt
    s_add_u32 s80, s80, 9216
    buffer_load_dwordx4 v[40:43], v163, s[36:39], s80 offen nt
    s_add_u32 s80, s80, 9216
    buffer_load_dwordx4 v[44:47], v163, s[36:39], s80 offen nt
    s_add_u32 s80, s80, 9216
    buffer_load_dwordx4 v[48:51], v163, s[36:39], s80 offen nt
    s_add_u32 s80, s80, 9216
    buffer_load_dwordx4 v[52:55], v163, s[36:39], s80 offen nt
    s_add_u32 s80, s80, 9216
    buffer_load_dwordx4 v[56:59], v163, s[36:39], s80 offen nt
    s_add_u32 s80, s80, 9216
    buffer_load_dwordx4 v[60:63], v163, s[36:39], s80 offen nt
    s_add_u32 s80, s80, 9216
    buffer_load_dwordx4 v[64:67], v163, s[36:39], s80 offen nt
    s_add_u32 s80, s80, 9216
    buffer_load_dwordx4 v[68:71], v163, s[36:39], s80 offen nt
    v_mov_b32 v165, 0
    s_mov_b32 s58, 0
L_lw_29:
    ds_read_b32 v164, v165 offset:12
    s_add_u32 s58, s58, 1
    s_waitcnt lgkmcnt(0)
    v_readfirstlane_b32 s62, v164
    s_nop 1
    s_cmp_ge_u32 s62, 1
    s_nop 0
    s_cbranch_scc1 L_lwd_30
    s_sleep 1
    s_cmp_lt_u32 s58, 0x400000
    s_cbranch_scc1 L_lw_29
L_lwd_30:
    v_mov_b32 v166, 0
    ds_read_b64 v[164:165], v166 offset:16
    s_waitcnt lgkmcnt(0)
    v_readfirstlane_b32 s48, v164
    v_readfirstlane_b32 s49, v165
    s_waitcnt vmcnt(14)
    v_perm_b32 v144, v12, v8, s50
    v_perm_b32 v12, v12, v8, s51
    v_mov_b32 v8, v144
    v_perm_b32 v144, v13, v9, s50
    v_perm_b32 v13, v13, v9, s51
    v_mov_b32 v9, v144
    v_perm_b32 v144, v14, v10, s50
    v_perm_b32 v14, v14, v10, s51
    v_mov_b32 v10, v144
    v_perm_b32 v144, v15, v11, s50
    v_perm_b32 v15, v15, v11, s51
    v_mov_b32 v11, v144
    s_waitcnt vmcnt(12)
    v_perm_b32 v144, v20, v16, s50
    v_perm_b32 v20, v20, v16, s51
    v_mov_b32 v16, v144
    v_perm_b32 v144, v21, v17, s50
    v_perm_b32 v21, v21, v17, s51
    v_mov_b32 v17, v144
    v_perm_b32 v144, v22, v18, s50
    v_perm_b32 v22, v22, v18, s51
    v_mov_b32 v18, v144
    v_perm_b32 v144, v23, v19, s50
    v_perm_b32 v23, v23, v19, s51
    v_mov_b32 v19, v144
    s_waitcnt vmcnt(10)
    v_perm_b32 v144, v28, v24, s50
    v_perm_b32 v28, v28, v24, s51
    v_mov_b32 v24, v144
    v_perm_b32 v144, v29, v25, s50
    v_perm_b32 v29, v29, v25, s51
    v_mov_b32 v25, v144
    v_perm_b32 v144, v30, v26, s50
    v_perm_b32 v30, v30, v26, s51
    v_mov_b32 v26, v144
    v_perm_b32 v144, v31, v27, s50
    v_perm_b32 v31, v31, v27, s51
    v_mov_b32 v27, v144
    s_waitcnt vmcnt(8)
    v_perm_b32 v144, v36, v32, s50
    v_perm_b32 v36, v36, v32, s51
    v_mov_b32 v32, v144
    v_perm_b32 v144, v37, v33, s50
    v_perm_b32 v37, v37, v33, s51
    v_mov_b32 v33, v144
    v_perm_b32 v144, v38, v34, s50
    v_perm_b32 v38, v38, v34, s51
    v_mov_b32 v34, v144
    v_perm_b32 v144, v39, v35, s50
    v_perm_b32 v39, v39, v35, s51
    v_mov_b32 v35, v144
    s_waitcnt vmcnt(6)
    v_perm_b32 v144, v44, v40, s50
    v_perm_b32 v44, v44, v40, s51
    v_mov_b32 v40, v144
    v_perm_b32 v144, v45, v41, s50
    v_perm_b32 v45, v45, v41, s51
    v_mov_b32 v41, v144
    v_perm_b32 v144, v46, v42, s50
    v_perm_b32 v46, v46, v42, s51
    v_mov_b32 v42, v144
    v_perm_b32 v144, v47, v43, s50
    v_perm_b32 v47, v47, v43, s51
    v_mov_b32 v43, v144
    s_waitcnt vmcnt(4)
    v_perm_b32 v144, v52, v48, s50
    v_perm_b32 v52, v52, v48, s51
    v_mov_b32 v48, v144
    v_perm_b32 v144, v53, v49, s50
    v_perm_b32 v53, v53, v49, s51
    v_mov_b32 v49, v144
    v_perm_b32 v144, v54, v50, s50
    v_perm_b32 v54, v54, v50, s51
    v_mov_b32 v50, v144
    v_perm_b32 v144, v55, v51, s50
    v_perm_b32 v55, v55, v51, s51
    v_mov_b32 v51, v144
    s_waitcnt vmcnt(2)
    v_perm_b32 v144, v60, v56, s50
    v_perm_b32 v60, v60, v56, s51
    v_mov_b32 v56, v144
    v_perm_b32 v144, v61, v57, s50
    v_perm_b32 v61, v61, v57, s51
    v_mov_b32 v57, v144
    v_perm_b32 v144, v62, v58, s50
    v_perm_b32 v62, v62, v58, s51
    v_mov_b32 v58, v144
    v_perm_b32 v144, v63, v59, s50
    v_perm_b32 v63, v63, v59, s51
    v_mov_b32 v59, v144
    s_waitcnt vmcnt(0)
    v_perm_b32 v144, v68, v64, s50
    v_perm_b32 v68, v68, v64, s51
    v_mov_b32 v64, v144
    v_perm_b32 v144, v69, v65, s50
    v_perm_b32 v69, v69, v65, s51
    v_mov_b32 v65, v144
    v_perm_b32 v144, v70, v66, s50
    v_perm_b32 v70, v70, v66, s51
    v_mov_b32 v66, v144
    v_perm_b32 v144, v71, v67, s50
    v_perm_b32 v71, v71, v67, s51
    v_mov_b32 v67, v144
    s_lshl_b32 s80, s78, 13
    s_add_u32 s80, s80, 0x40000
    s_add_u32 s81, s80, 4096
    v_lshlrev_b32 v145, 4, v1
    s_mov_b32 s58, 0
L_x1f_r_31:
    buffer_load_dwordx4 v[80:83], v145, s[44:47], s80 offen offset:0 sc1
    buffer_load_dwordx4 v[84:87], v145, s[44:47], s80 offen offset:1024 sc1
    buffer_load_dwordx4 v[88:91], v145, s[44:47], s80 offen offset:2048 sc1
    buffer_load_dwordx4 v[92:95], v145, s[44:47], s80 offen offset:3072 sc1
    buffer_load_dwordx4 v[96:99], v145, s[44:47], s81 offen offset:0 sc1
    buffer_load_dwordx4 v[100:103], v145, s[44:47], s81 offen offset:1024 sc1
    buffer_load_dwordx4 v[104:107], v145, s[44:47], s81 offen offset:2048 sc1
    buffer_load_dwordx4 v[108:111], v145, s[44:47], s81 offen offset:3072 sc1
    s_add_u32 s58, s58, 1
    s_waitcnt vmcnt(0)
    v_cmp_ne_u64 s[64:65], s[48:49], v[82:83]
    v_cmp_ne_u64 vcc, s[48:49], v[86:87]
    s_nop 1
    s_or_b64 s[64:65], s[64:65], vcc
    v_cmp_ne_u64 vcc, s[48:49], v[90:91]
    s_nop 1
    s_or_b64 s[64:65], s[64:65], vcc
    v_cmp_ne_u64 vcc, s[48:49], v[94:95]
    s_nop 1
    s_or_b64 s[64:65], s[64:65], vcc
    v_cmp_ne_u64 vcc, s[48:49], v[98:99]
    s_nop 1
    s_or_b64 s[64:65], s[64:65], vcc
    v_cmp_ne_u64 vcc, s[48:49], v[102:103]
    s_nop 1
    s_or_b64 s[64:65], s[64:65], vcc
    v_cmp_ne_u64 vcc, s[48:49], v[106:107]
    s_nop 1
    s_or_b64 s[64:65], s[64:65], vcc
    v_cmp_ne_u64 vcc, s[48:49], v[110:111]
    s_nop 1
    s_or_b64 s[64:65], s[64:65], vcc
    s_cmp_eq_u64 s[64:65], 0
    s_cbranch_scc1 L_x1f_ok_32
    s_cmp_lt_u32 s58, 0x40000
    s_cbranch_scc1 L_x1f_r_31
L_x1f_ok_32:
    v_add_f32 v80, v80, v84
    v_add_f32 v81, v81, v85
    v_mov_b32 v120, v80
    s_nop 1
    v_permlane32_swap_b32 v80, v120
    v_add_f32 v80, v80, v120
    v_mov_b32 v121, v81
    s_nop 1
    v_permlane32_swap_b32 v81, v121
    v_add_f32 v81, v81, v121
    v_add_f32 v88, v88, v92
    v_add_f32 v89, v89, v93
    v_mov_b32 v120, v88
    s_nop 1
    v_permlane32_swap_b32 v88, v120
    v_add_f32 v88, v88, v120
    v_mov_b32 v121, v89
    s_nop 1
    v_permlane32_swap_b32 v89, v121
    v_add_f32 v89, v89, v121
    v_add_f32 v96, v96, v100
    v_add_f32 v97, v97, v101
    v_mov_b32 v120, v96
    s_nop 1
    v_permlane32_swap_b32 v96, v120
    v_add_f32 v96, v96, v120
    v_mov_b32 v121, v97
    s_nop 1
    v_permlane32_swap_b32 v97, v121
    v_add_f32 v97, v97, v121
    v_add_f32 v104, v104, v108
    v_add_f32 v105, v105, v109
    v_mov_b32 v120, v104
    s_nop 1
    v_permlane32_swap_b32 v104, v120
    v_add_f32 v104, v104, v120
    v_mov_b32 v121, v105
    s_nop 1
    v_permlane32_swap_b32 v105, v121
    v_add_f32 v105, v105, v121
    v_cvt_pk_bf16_f32 v80, v80, v80
    v_lshlrev_b32 v80, 16, v80
    v_cvt_pk_bf16_f32 v96, v96, v96
    v_lshlrev_b32 v96, 16, v96
    v_mul_f32 v120, 0xbfb8aa3b, v80
    v_exp_f32 v120, v120
    s_nop 0
    v_add_f32 v120, 1.0, v120
    v_rcp_f32 v120, v120
    s_nop 0
    v_mul_f32 v80, v80, v120
    v_cvt_pk_bf16_f32 v80, v80, v80
    v_lshlrev_b32 v80, 16, v80
    v_mul_f32 v80, v80, v96
    v_cvt_pk_bf16_f32 v81, v81, v81
    v_lshlrev_b32 v81, 16, v81
    v_cvt_pk_bf16_f32 v97, v97, v97
    v_lshlrev_b32 v97, 16, v97
    v_mul_f32 v120, 0xbfb8aa3b, v81
    v_exp_f32 v120, v120
    s_nop 0
    v_add_f32 v120, 1.0, v120
    v_rcp_f32 v120, v120
    s_nop 0
    v_mul_f32 v81, v81, v120
    v_cvt_pk_bf16_f32 v81, v81, v81
    v_lshlrev_b32 v81, 16, v81
    v_mul_f32 v81, v81, v97
    v_cvt_pk_bf16_f32 v80, v80, v81
    v_and_b32 v124, 31, v1
    v_lshrrev_b32 v126, 3, v124
    v_lshlrev_b32 v126, 5, v126
    v_and_b32 v127, 3, v124
    v_lshl_add_u32 v126, v127, 3, v126
    v_bfe_u32 v127, v124, 2, 1
    v_lshl_add_u32 v126, v127, 1, v126
    v_add_u32 v126, s60, v126
    ds_write_b16 v126, v80
    ds_write_b16_d16_hi v126, v80 offset:4
    v_cvt_pk_bf16_f32 v88, v88, v88
    v_lshlrev_b32 v88, 16, v88
    v_cvt_pk_bf16_f32 v104, v104, v104
    v_lshlrev_b32 v104, 16, v104
    v_mul_f32 v120, 0xbfb8aa3b, v88
    v_exp_f32 v120, v120
    s_nop 0
    v_add_f32 v120, 1.0, v120
    v_rcp_f32 v120, v120
    s_nop 0
    v_mul_f32 v88, v88, v120
    v_cvt_pk_bf16_f32 v88, v88, v88
    v_lshlrev_b32 v88, 16, v88
    v_mul_f32 v88, v88, v104
    v_cvt_pk_bf16_f32 v89, v89, v89
    v_lshlrev_b32 v89, 16, v89
    v_cvt_pk_bf16_f32 v105, v105, v105
    v_lshlrev_b32 v105, 16, v105
    v_mul_f32 v120, 0xbfb8aa3b, v89
    v_exp_f32 v120, v120
    s_nop 0
    v_add_f32 v120, 1.0, v120
    v_rcp_f32 v120, v120
    s_nop 0
    v_mul_f32 v89, v89, v120
    v_cvt_pk_bf16_f32 v89, v89, v89
    v_lshlrev_b32 v89, 16, v89
    v_mul_f32 v89, v89, v105
    v_cvt_pk_bf16_f32 v88, v88, v89
    v_and_b32 v124, 31, v1
    v_add_u32 v124, 32, v124
    v_lshrrev_b32 v126, 3, v124
    v_lshlrev_b32 v126, 5, v126
    v_and_b32 v127, 3, v124
    v_lshl_add_u32 v126, v127, 3, v126
    v_bfe_u32 v127, v124, 2, 1
    v_lshl_add_u32 v126, v127, 1, v126
    v_add_u32 v126, s60, v126
    ds_write_b16 v126, v88
    ds_write_b16_d16_hi v126, v88 offset:4
    v_lshrrev_b32 v126, 3, v1
    v_lshlrev_b32 v126, 2, v126
    v_add_u32 v126, s60, v126
    ds_read_b32 v128, v126 offset:0
    ds_read_b32 v129, v126 offset:32
    ds_read_b32 v130, v126 offset:64
    ds_read_b32 v131, v126 offset:96
    ds_read_b32 v132, v126 offset:128
    ds_read_b32 v133, v126 offset:160
    ds_read_b32 v134, v126 offset:192
    ds_read_b32 v135, v126 offset:224
    s_waitcnt lgkmcnt(7)
    v_dot2_f32_bf16 v152, v8, v128, 0
    v_dot2_f32_bf16 v153, v12, v128, 0
    v_dot2_f32_bf16 v154, v9, v128, 0
    v_dot2_f32_bf16 v155, v13, v128, 0
    v_dot2_f32_bf16 v156, v10, v128, 0
    v_dot2_f32_bf16 v157, v14, v128, 0
    v_dot2_f32_bf16 v158, v11, v128, 0
    v_dot2_f32_bf16 v159, v15, v128, 0
    s_waitcnt lgkmcnt(6)
    v_dot2c_f32_bf16 v152, v16, v129
    v_dot2c_f32_bf16 v153, v20, v129
    v_dot2c_f32_bf16 v154, v17, v129
    v_dot2c_f32_bf16 v155, v21, v129
    v_dot2c_f32_bf16 v156, v18, v129
    v_dot2c_f32_bf16 v157, v22, v129
    v_dot2c_f32_bf16 v158, v19, v129
    v_dot2c_f32_bf16 v159, v23, v129
    s_waitcnt lgkmcnt(5)
    v_dot2c_f32_bf16 v152, v24, v130
    v_dot2c_f32_bf16 v153, v28, v130
    v_dot2c_f32_bf16 v154, v25, v130
    v_dot2c_f32_bf16 v155, v29, v130
    v_dot2c_f32_bf16 v156, v26, v130
    v_dot2c_f32_bf16 v157, v30, v130
    v_dot2c_f32_bf16 v158, v27, v130
    v_dot2c_f32_bf16 v159, v31, v130
    s_waitcnt lgkmcnt(4)
    v_dot2c_f32_bf16 v152, v32, v131
    v_dot2c_f32_bf16 v153, v36, v131
    v_dot2c_f32_bf16 v154, v33, v131
    v_dot2c_f32_bf16 v155, v37, v131
    v_dot2c_f32_bf16 v156, v34, v131
    v_dot2c_f32_bf16 v157, v38, v131
    v_dot2c_f32_bf16 v158, v35, v131
    v_dot2c_f32_bf16 v159, v39, v131
    s_waitcnt lgkmcnt(3)
    v_dot2c_f32_bf16 v152, v40, v132
    v_dot2c_f32_bf16 v153, v44, v132
    v_dot2c_f32_bf16 v154, v41, v132
    v_dot2c_f32_bf16 v155, v45, v132
    v_dot2c_f32_bf16 v156, v42, v132
    v_dot2c_f32_bf16 v157, v46, v132
    v_dot2c_f32_bf16 v158, v43, v132
    v_dot2c_f32_bf16 v159, v47, v132
    s_waitcnt lgkmcnt(2)
    v_dot2c_f32_bf16 v152, v48, v133
    v_dot2c_f32_bf16 v153, v52, v133
    v_dot2c_f32_bf16 v154, v49, v133
    v_dot2c_f32_bf16 v155, v53, v133
    v_dot2c_f32_bf16 v156, v50, v133
    v_dot2c_f32_bf16 v157, v54, v133
    v_dot2c_f32_bf16 v158, v51, v133
    v_dot2c_f32_bf16 v159, v55, v133
    s_waitcnt lgkmcnt(1)
    v_dot2c_f32_bf16 v152, v56, v134
    v_dot2c_f32_bf16 v153, v60, v134
    v_dot2c_f32_bf16 v154, v57, v134
    v_dot2c_f32_bf16 v155, v61, v134
    v_dot2c_f32_bf16 v156, v58, v134
    v_dot2c_f32_bf16 v157, v62, v134
    v_dot2c_f32_bf16 v158, v59, v134
    v_dot2c_f32_bf16 v159, v63, v134
    s_waitcnt lgkmcnt(0)
    v_dot2c_f32_bf16 v152, v64, v135
    v_dot2c_f32_bf16 v153, v68, v135
    v_dot2c_f32_bf16 v154, v65, v135
    v_dot2c_f32_bf16 v155, v69, v135
    v_dot2c_f32_bf16 v156, v66, v135
    v_dot2c_f32_bf16 v157, v70, v135
    v_dot2c_f32_bf16 v158, v67, v135
    v_dot2c_f32_bf16 v159, v71, v135
    s_mul_i32 s82, s79, 36
    s_add_u32 s82, s82, s78
    s_lshl_b32 s82, s82, 9
    s_add_u32 s82, s82, 0x1c0000
    v_permlane32_swap_b32 v152, v156
    v_permlane32_swap_b32 v153, v157
    v_permlane32_swap_b32 v154, v158
    v_permlane32_swap_b32 v155, v159
    v_add_f32 v152, v152, v156
    v_add_f32 v153, v153, v157
    v_add_f32 v154, v154, v158
    v_add_f32 v155, v155, v159
    s_nop 0
    v_permlane16_swap_b32 v152, v154
    v_permlane16_swap_b32 v153, v155
    v_add_f32 v152, v152, v154
    v_add_f32 v153, v153, v155
    s_nop 0
    v_add_f32_dpp v152, v152, v152 row_ror:8 row_mask:0xf bank_mask:0x3
    s_nop 1
    v_add_f32_dpp v152, v153, v153 row_ror:8 row_mask:0xf bank_mask:0xc
    v_mov_b32 v136, v152
    s_nop 0
    v_mov_b32_dpp v137, v152 row_ror:8 row_mask:0xf bank_mask:0xf
    v_mov_b32 v138, s48
    v_mov_b32 v139, s49
    v_and_b32 v140, 7, v1
    v_lshlrev_b32 v140, 6, v140
    v_lshrrev_b32 v141, 5, v1
    v_lshl_add_u32 v140, v141, 5, v140
    v_bfe_u32 v141, v1, 4, 1
    v_lshl_add_u32 v140, v141, 4, v140
    s_mov_b32 exec_lo, 0x00ff00ff
    s_mov_b32 exec_hi, 0x00ff00ff
    buffer_store_dwordx4 v[136:139], v140, s[44:47], s82 offen sc1
    s_mov_b64 exec, -1
    s_branch L_exit_recurrent_scan__sliding_block_cached__swiglu_ffn__decode_kernel
L_t2_9:
    s_cmp_lg_u32 s3, 10
    s_cbranch_scc1 L_t3_10
    s_mov_b32 s95, s2
    s_mov_b32 s94, s2
    s_lshl_b32 s61, s2, 1
    s_add_u32 s61, s61, 1
    s_and_b32 s72, s61, 3
    s_lshr_b32 s73, s61, 4
    s_bfe_u32 s74, s61, 0x10002
    s_lshl_b32 s70, s73, 1
    s_add_u32 s70, s70, s74
    s_lshl_b32 s70, s70, 7
    s_mul_i32 s75, s72, 1327104
    s_add_u32 s70, s70, s75
    s_mul_i32 s75, s72, 288
    s_add_u32 s75, s75, s60
    v_lshrrev_b32 v161, 3, v1
    v_lshlrev_b32 v161, 2, v161
    v_add_u32 v161, s75, v161
    ds_read_b32 v152, v161 offset:0
    ds_read_b32 v153, v161 offset:32
    ds_read_b32 v154, v161 offset:64
    ds_read_b32 v155, v161 offset:96
    ds_read_b32 v156, v161 offset:128
    ds_read_b32 v157, v161 offset:160
    ds_read_b32 v158, v161 offset:192
    ds_read_b32 v159, v161 offset:224
    ds_read_b32 v160, v161 offset:256
    v_mov_b32 v165, 0
    s_mov_b32 s58, 0
L_lw_36:
    ds_read_b32 v164, v165 offset:4
    s_add_u32 s58, s58, 1
    s_waitcnt lgkmcnt(0)
    v_readfirstlane_b32 s62, v164
    s_nop 1
    s_cmp_ge_u32 s62, 8
    s_nop 0
    s_cbranch_scc1 L_lwd_37
    s_sleep 1
    s_cmp_lt_u32 s58, 0x400000
    s_cbranch_scc1 L_lw_36
L_lwd_37:
    v_lshrrev_b32 v163, 3, v1
    s_mov_b32 s63, 9216
    v_mul_lo_u32 v163, v163, s63
    v_and_b32 v164, 7, v1
    v_lshl_add_u32 v163, v164, 4, v163
    s_bitcmp1_b32 s61, 3
    s_cbranch_scc1 L_gup_38
    buffer_load_dwordx4 v[8:11], v163, s[28:31], s70 offen nt
    s_add_u32 s70, s70, 73728
    buffer_load_dwordx4 v[12:15], v163, s[28:31], s70 offen nt
    s_add_u32 s70, s70, 73728
    buffer_load_dwordx4 v[16:19], v163, s[28:31], s70 offen nt
    s_add_u32 s70, s70, 73728
    buffer_load_dwordx4 v[20:23], v163, s[28:31], s70 offen nt
    s_add_u32 s70, s70, 73728
    buffer_load_dwordx4 v[24:27], v163, s[28:31], s70 offen nt
    s_add_u32 s70, s70, 73728
    buffer_load_dwordx4 v[28:31], v163, s[28:31], s70 offen nt
    s_add_u32 s70, s70, 73728
    buffer_load_dwordx4 v[32:35], v163, s[28:31], s70 offen nt
    s_add_u32 s70, s70, 73728
    buffer_load_dwordx4 v[36:39], v163, s[28:31], s70 offen nt
    s_add_u32 s70, s70, 73728
    buffer_load_dwordx4 v[40:43], v163, s[28:31], s70 offen nt
    s_add_u32 s70, s70, 73728
    buffer_load_dwordx4 v[44:47], v163, s[28:31], s70 offen nt
    s_add_u32 s70, s70, 73728
    buffer_load_dwordx4 v[48:51], v163, s[28:31], s70 offen nt
    s_add_u32 s70, s70, 73728
    buffer_load_dwordx4 v[52:55], v163, s[28:31], s70 offen nt
    s_add_u32 s70, s70, 73728
    buffer_load_dwordx4 v[56:59], v163, s[28:31], s70 offen nt
    s_add_u32 s70, s70, 73728
    buffer_load_dwordx4 v[60:63], v163, s[28:31], s70 offen nt
    s_add_u32 s70, s70, 73728
    buffer_load_dwordx4 v[64:67], v163, s[28:31], s70 offen nt
    s_add_u32 s70, s70, 73728
    buffer_load_dwordx4 v[68:71], v163, s[28:31], s70 offen nt
    s_add_u32 s70, s70, 73728
    buffer_load_dwordx4 v[72:75], v163, s[28:31], s70 offen nt
    s_add_u32 s70, s70, 73728
    buffer_load_dwordx4 v[76:79], v163, s[28:31], s70 offen nt
    s_branch L_gdn_39
L_gup_38:
    buffer_load_dwordx4 v[8:11], v163, s[32:35], s70 offen nt
    s_add_u32 s70, s70, 73728
    buffer_load_dwordx4 v[12:15], v163, s[32:35], s70 offen nt
    s_add_u32 s70, s70, 73728
    buffer_load_dwordx4 v[16:19], v163, s[32:35], s70 offen nt
    s_add_u32 s70, s70, 73728
    buffer_load_dwordx4 v[20:23], v163, s[32:35], s70 offen nt
    s_add_u32 s70, s70, 73728
    buffer_load_dwordx4 v[24:27], v163, s[32:35], s70 offen nt
    s_add_u32 s70, s70, 73728
    buffer_load_dwordx4 v[28:31], v163, s[32:35], s70 offen nt
    s_add_u32 s70, s70, 73728
    buffer_load_dwordx4 v[32:35], v163, s[32:35], s70 offen nt
    s_add_u32 s70, s70, 73728
    buffer_load_dwordx4 v[36:39], v163, s[32:35], s70 offen nt
    s_add_u32 s70, s70, 73728
    buffer_load_dwordx4 v[40:43], v163, s[32:35], s70 offen nt
    s_add_u32 s70, s70, 73728
    buffer_load_dwordx4 v[44:47], v163, s[32:35], s70 offen nt
    s_add_u32 s70, s70, 73728
    buffer_load_dwordx4 v[48:51], v163, s[32:35], s70 offen nt
    s_add_u32 s70, s70, 73728
    buffer_load_dwordx4 v[52:55], v163, s[32:35], s70 offen nt
    s_add_u32 s70, s70, 73728
    buffer_load_dwordx4 v[56:59], v163, s[32:35], s70 offen nt
    s_add_u32 s70, s70, 73728
    buffer_load_dwordx4 v[60:63], v163, s[32:35], s70 offen nt
    s_add_u32 s70, s70, 73728
    buffer_load_dwordx4 v[64:67], v163, s[32:35], s70 offen nt
    s_add_u32 s70, s70, 73728
    buffer_load_dwordx4 v[68:71], v163, s[32:35], s70 offen nt
    s_add_u32 s70, s70, 73728
    buffer_load_dwordx4 v[72:75], v163, s[32:35], s70 offen nt
    s_add_u32 s70, s70, 73728
    buffer_load_dwordx4 v[76:79], v163, s[32:35], s70 offen nt
L_gdn_39:
    v_mov_b32 v164, 0
    v_mov_b32 v165, 1
    s_mov_b64 exec, 1
    ds_add_u32 v164, v165 offset:24
    s_mov_b64 exec, -1
    s_waitcnt vmcnt(16)
    v_perm_b32 v161, v12, v8, s50
    v_perm_b32 v162, v12, v8, s51
    v_dot2_f32_bf16 v144, v161, v152, 0
    v_dot2_f32_bf16 v145, v162, v152, 0
    v_perm_b32 v161, v13, v9, s50
    v_perm_b32 v162, v13, v9, s51
    v_dot2_f32_bf16 v146, v161, v152, 0
    v_dot2_f32_bf16 v147, v162, v152, 0
    v_perm_b32 v161, v14, v10, s50
    v_perm_b32 v162, v14, v10, s51
    v_dot2_f32_bf16 v148, v161, v152, 0
    v_dot2_f32_bf16 v149, v162, v152, 0
    v_perm_b32 v161, v15, v11, s50
    v_perm_b32 v162, v15, v11, s51
    v_dot2_f32_bf16 v150, v161, v152, 0
    v_dot2_f32_bf16 v151, v162, v152, 0
    s_waitcnt vmcnt(14)
    v_perm_b32 v161, v20, v16, s50
    v_perm_b32 v162, v20, v16, s51
    v_dot2c_f32_bf16 v144, v161, v153
    v_dot2c_f32_bf16 v145, v162, v153
    v_perm_b32 v161, v21, v17, s50
    v_perm_b32 v162, v21, v17, s51
    v_dot2c_f32_bf16 v146, v161, v153
    v_dot2c_f32_bf16 v147, v162, v153
    v_perm_b32 v161, v22, v18, s50
    v_perm_b32 v162, v22, v18, s51
    v_dot2c_f32_bf16 v148, v161, v153
    v_dot2c_f32_bf16 v149, v162, v153
    v_perm_b32 v161, v23, v19, s50
    v_perm_b32 v162, v23, v19, s51
    v_dot2c_f32_bf16 v150, v161, v153
    v_dot2c_f32_bf16 v151, v162, v153
    s_waitcnt vmcnt(12)
    v_perm_b32 v161, v28, v24, s50
    v_perm_b32 v162, v28, v24, s51
    v_dot2c_f32_bf16 v144, v161, v154
    v_dot2c_f32_bf16 v145, v162, v154
    v_perm_b32 v161, v29, v25, s50
    v_perm_b32 v162, v29, v25, s51
    v_dot2c_f32_bf16 v146, v161, v154
    v_dot2c_f32_bf16 v147, v162, v154
    v_perm_b32 v161, v30, v26, s50
    v_perm_b32 v162, v30, v26, s51
    v_dot2c_f32_bf16 v148, v161, v154
    v_dot2c_f32_bf16 v149, v162, v154
    v_perm_b32 v161, v31, v27, s50
    v_perm_b32 v162, v31, v27, s51
    v_dot2c_f32_bf16 v150, v161, v154
    v_dot2c_f32_bf16 v151, v162, v154
    s_waitcnt vmcnt(10)
    v_perm_b32 v161, v36, v32, s50
    v_perm_b32 v162, v36, v32, s51
    v_dot2c_f32_bf16 v144, v161, v155
    v_dot2c_f32_bf16 v145, v162, v155
    v_perm_b32 v161, v37, v33, s50
    v_perm_b32 v162, v37, v33, s51
    v_dot2c_f32_bf16 v146, v161, v155
    v_dot2c_f32_bf16 v147, v162, v155
    v_perm_b32 v161, v38, v34, s50
    v_perm_b32 v162, v38, v34, s51
    v_dot2c_f32_bf16 v148, v161, v155
    v_dot2c_f32_bf16 v149, v162, v155
    v_perm_b32 v161, v39, v35, s50
    v_perm_b32 v162, v39, v35, s51
    v_dot2c_f32_bf16 v150, v161, v155
    v_dot2c_f32_bf16 v151, v162, v155
    s_waitcnt vmcnt(8)
    v_perm_b32 v161, v44, v40, s50
    v_perm_b32 v162, v44, v40, s51
    v_dot2c_f32_bf16 v144, v161, v156
    v_dot2c_f32_bf16 v145, v162, v156
    v_perm_b32 v161, v45, v41, s50
    v_perm_b32 v162, v45, v41, s51
    v_dot2c_f32_bf16 v146, v161, v156
    v_dot2c_f32_bf16 v147, v162, v156
    v_perm_b32 v161, v46, v42, s50
    v_perm_b32 v162, v46, v42, s51
    v_dot2c_f32_bf16 v148, v161, v156
    v_dot2c_f32_bf16 v149, v162, v156
    v_perm_b32 v161, v47, v43, s50
    v_perm_b32 v162, v47, v43, s51
    v_dot2c_f32_bf16 v150, v161, v156
    v_dot2c_f32_bf16 v151, v162, v156
    s_waitcnt vmcnt(6)
    v_perm_b32 v161, v52, v48, s50
    v_perm_b32 v162, v52, v48, s51
    v_dot2c_f32_bf16 v144, v161, v157
    v_dot2c_f32_bf16 v145, v162, v157
    v_perm_b32 v161, v53, v49, s50
    v_perm_b32 v162, v53, v49, s51
    v_dot2c_f32_bf16 v146, v161, v157
    v_dot2c_f32_bf16 v147, v162, v157
    v_perm_b32 v161, v54, v50, s50
    v_perm_b32 v162, v54, v50, s51
    v_dot2c_f32_bf16 v148, v161, v157
    v_dot2c_f32_bf16 v149, v162, v157
    v_perm_b32 v161, v55, v51, s50
    v_perm_b32 v162, v55, v51, s51
    v_dot2c_f32_bf16 v150, v161, v157
    v_dot2c_f32_bf16 v151, v162, v157
    s_waitcnt vmcnt(4)
    v_perm_b32 v161, v60, v56, s50
    v_perm_b32 v162, v60, v56, s51
    v_dot2c_f32_bf16 v144, v161, v158
    v_dot2c_f32_bf16 v145, v162, v158
    v_perm_b32 v161, v61, v57, s50
    v_perm_b32 v162, v61, v57, s51
    v_dot2c_f32_bf16 v146, v161, v158
    v_dot2c_f32_bf16 v147, v162, v158
    v_perm_b32 v161, v62, v58, s50
    v_perm_b32 v162, v62, v58, s51
    v_dot2c_f32_bf16 v148, v161, v158
    v_dot2c_f32_bf16 v149, v162, v158
    v_perm_b32 v161, v63, v59, s50
    v_perm_b32 v162, v63, v59, s51
    v_dot2c_f32_bf16 v150, v161, v158
    v_dot2c_f32_bf16 v151, v162, v158
    s_waitcnt vmcnt(2)
    v_perm_b32 v161, v68, v64, s50
    v_perm_b32 v162, v68, v64, s51
    v_dot2c_f32_bf16 v144, v161, v159
    v_dot2c_f32_bf16 v145, v162, v159
    v_perm_b32 v161, v69, v65, s50
    v_perm_b32 v162, v69, v65, s51
    v_dot2c_f32_bf16 v146, v161, v159
    v_dot2c_f32_bf16 v147, v162, v159
    v_perm_b32 v161, v70, v66, s50
    v_perm_b32 v162, v70, v66, s51
    v_dot2c_f32_bf16 v148, v161, v159
    v_dot2c_f32_bf16 v149, v162, v159
    v_perm_b32 v161, v71, v67, s50
    v_perm_b32 v162, v71, v67, s51
    v_dot2c_f32_bf16 v150, v161, v159
    v_dot2c_f32_bf16 v151, v162, v159
    s_waitcnt vmcnt(0)
    v_perm_b32 v161, v76, v72, s50
    v_perm_b32 v162, v76, v72, s51
    v_dot2c_f32_bf16 v144, v161, v160
    v_dot2c_f32_bf16 v145, v162, v160
    v_perm_b32 v161, v77, v73, s50
    v_perm_b32 v162, v77, v73, s51
    v_dot2c_f32_bf16 v146, v161, v160
    v_dot2c_f32_bf16 v147, v162, v160
    v_perm_b32 v161, v78, v74, s50
    v_perm_b32 v162, v78, v74, s51
    v_dot2c_f32_bf16 v148, v161, v160
    v_dot2c_f32_bf16 v149, v162, v160
    v_perm_b32 v161, v79, v75, s50
    v_perm_b32 v162, v79, v75, s51
    v_dot2c_f32_bf16 v150, v161, v160
    v_dot2c_f32_bf16 v151, v162, v160
    s_lshl_b32 s71, s61, 9
    s_add_u32 s71, s71, 0x40000
    v_mov_b32 v165, 0
    s_mov_b32 s58, 0
L_lw_40:
    ds_read_b32 v164, v165 offset:12
    s_add_u32 s58, s58, 1
    s_waitcnt lgkmcnt(0)
    v_readfirstlane_b32 s62, v164
    s_nop 1
    s_cmp_ge_u32 s62, 1
    s_nop 0
    s_cbranch_scc1 L_lwd_41
    s_sleep 1
    s_cmp_lt_u32 s58, 0x400000
    s_cbranch_scc1 L_lw_40
L_lwd_41:
    v_mov_b32 v166, 0
    ds_read_b64 v[164:165], v166 offset:16
    s_waitcnt lgkmcnt(0)
    v_readfirstlane_b32 s48, v164
    v_readfirstlane_b32 s49, v165
    v_permlane32_swap_b32 v144, v148
    v_permlane32_swap_b32 v145, v149
    v_permlane32_swap_b32 v146, v150
    v_permlane32_swap_b32 v147, v151
    v_add_f32 v144, v144, v148
    v_add_f32 v145, v145, v149
    v_add_f32 v146, v146, v150
    v_add_f32 v147, v147, v151
    s_nop 0
    v_permlane16_swap_b32 v144, v146
    v_permlane16_swap_b32 v145, v147
    v_add_f32 v144, v144, v146
    v_add_f32 v145, v145, v147
    s_nop 0
    v_add_f32_dpp v144, v144, v144 row_ror:8 row_mask:0xf bank_mask:0x3
    s_nop 1
    v_add_f32_dpp v144, v145, v145 row_ror:8 row_mask:0xf bank_mask:0xc
    v_mov_b32 v8, v144
    s_nop 0
    v_mov_b32_dpp v9, v144 row_ror:8 row_mask:0xf bank_mask:0xf
    v_mov_b32 v10, s48
    v_mov_b32 v11, s49
    v_and_b32 v12, 7, v1
    v_lshlrev_b32 v12, 6, v12
    v_lshrrev_b32 v13, 5, v1
    v_lshl_add_u32 v12, v13, 5, v12
    v_bfe_u32 v13, v1, 4, 1
    v_lshl_add_u32 v12, v13, 4, v12
    s_mov_b32 exec_lo, 0x00ff00ff
    s_mov_b32 exec_hi, 0x00ff00ff
    buffer_store_dwordx4 v[8:11], v12, s[44:47], s71 offen sc1
    s_mov_b64 exec, -1
    s_cmp_ge_u32 s95, 32
    s_cbranch_scc1 L_e2_33
    s_add_u32 s61, s95, 256
    s_mul_i32 s78, s61, 7282
    s_lshr_b32 s78, s78, 16
    s_mul_i32 s79, s78, 9
    s_sub_u32 s79, s61, s79
    s_mul_i32 s80, s78, 147456
    s_lshl_b32 s82, s79, 7
    s_add_u32 s80, s80, s82
    v_lshrrev_b32 v163, 3, v1
    s_mov_b32 s63, 1152
    v_mul_lo_u32 v163, v163, s63
    v_and_b32 v164, 7, v1
    v_lshl_add_u32 v163, v164, 4, v163
    v_mov_b32 v165, 0
    s_mov_b32 s58, 0
L_lw_42:
    ds_read_b32 v164, v165 offset:24
    s_add_u32 s58, s58, 1
    s_waitcnt lgkmcnt(0)
    v_readfirstlane_b32 s62, v164
    s_nop 1
    s_cmp_ge_u32 s62, 3
    s_nop 0
    s_cbranch_scc1 L_lwd_43
    s_sleep 1
    s_cmp_lt_u32 s58, 0x400000
    s_cbranch_scc1 L_lw_42
L_lwd_43:
    buffer_load_dwordx4 v[8:11], v163, s[24:27], s80 offen nt
    s_add_u32 s80, s80, 9216
    buffer_load_dwordx4 v[12:15], v163, s[24:27], s80 offen nt
    s_add_u32 s80, s80, 9216
    buffer_load_dwordx4 v[16:19], v163, s[24:27], s80 offen nt
    s_add_u32 s80, s80, 9216
    buffer_load_dwordx4 v[20:23], v163, s[24:27], s80 offen nt
    s_add_u32 s80, s80, 9216
    buffer_load_dwordx4 v[24:27], v163, s[24:27], s80 offen nt
    s_add_u32 s80, s80, 9216
    buffer_load_dwordx4 v[28:31], v163, s[24:27], s80 offen nt
    s_add_u32 s80, s80, 9216
    buffer_load_dwordx4 v[32:35], v163, s[24:27], s80 offen nt
    s_add_u32 s80, s80, 9216
    buffer_load_dwordx4 v[36:39], v163, s[24:27], s80 offen nt
    s_add_u32 s80, s80, 9216
    buffer_load_dwordx4 v[40:43], v163, s[24:27], s80 offen nt
    s_add_u32 s80, s80, 9216
    buffer_load_dwordx4 v[44:47], v163, s[24:27], s80 offen nt
    s_add_u32 s80, s80, 9216
    buffer_load_dwordx4 v[48:51], v163, s[24:27], s80 offen nt
    s_add_u32 s80, s80, 9216
    buffer_load_dwordx4 v[52:55], v163, s[24:27], s80 offen nt
    s_add_u32 s80, s80, 9216
    buffer_load_dwordx4 v[56:59], v163, s[24:27], s80 offen nt
    s_add_u32 s80, s80, 9216
    buffer_load_dwordx4 v[60:63], v163, s[24:27], s80 offen nt
    s_add_u32 s80, s80, 9216
    buffer_load_dwordx4 v[64:67], v163, s[24:27], s80 offen nt
    s_add_u32 s80, s80, 9216
    buffer_load_dwordx4 v[68:71], v163, s[24:27], s80 offen nt
    v_mov_b32 v165, 0
    s_mov_b32 s58, 0
L_lw_44:
    ds_read_b32 v164, v165 offset:12
    s_add_u32 s58, s58, 1
    s_waitcnt lgkmcnt(0)
    v_readfirstlane_b32 s62, v164
    s_nop 1
    s_cmp_ge_u32 s62, 1
    s_nop 0
    s_cbranch_scc1 L_lwd_45
    s_sleep 1
    s_cmp_lt_u32 s58, 0x400000
    s_cbranch_scc1 L_lw_44
L_lwd_45:
    v_mov_b32 v166, 0
    ds_read_b64 v[164:165], v166 offset:16
    s_waitcnt lgkmcnt(0)
    v_readfirstlane_b32 s48, v164
    v_readfirstlane_b32 s49, v165
    s_waitcnt vmcnt(14)
    v_perm_b32 v148, v12, v8, s50
    v_perm_b32 v12, v12, v8, s51
    v_mov_b32 v8, v148
    v_perm_b32 v148, v13, v9, s50
    v_perm_b32 v13, v13, v9, s51
    v_mov_b32 v9, v148
    v_perm_b32 v148, v14, v10, s50
    v_perm_b32 v14, v14, v10, s51
    v_mov_b32 v10, v148
    v_perm_b32 v148, v15, v11, s50
    v_perm_b32 v15, v15, v11, s51
    v_mov_b32 v11, v148
    s_waitcnt vmcnt(12)
    v_perm_b32 v148, v20, v16, s50
    v_perm_b32 v20, v20, v16, s51
    v_mov_b32 v16, v148
    v_perm_b32 v148, v21, v17, s50
    v_perm_b32 v21, v21, v17, s51
    v_mov_b32 v17, v148
    v_perm_b32 v148, v22, v18, s50
    v_perm_b32 v22, v22, v18, s51
    v_mov_b32 v18, v148
    v_perm_b32 v148, v23, v19, s50
    v_perm_b32 v23, v23, v19, s51
    v_mov_b32 v19, v148
    s_waitcnt vmcnt(10)
    v_perm_b32 v148, v28, v24, s50
    v_perm_b32 v28, v28, v24, s51
    v_mov_b32 v24, v148
    v_perm_b32 v148, v29, v25, s50
    v_perm_b32 v29, v29, v25, s51
    v_mov_b32 v25, v148
    v_perm_b32 v148, v30, v26, s50
    v_perm_b32 v30, v30, v26, s51
    v_mov_b32 v26, v148
    v_perm_b32 v148, v31, v27, s50
    v_perm_b32 v31, v31, v27, s51
    v_mov_b32 v27, v148
    s_waitcnt vmcnt(8)
    v_perm_b32 v148, v36, v32, s50
    v_perm_b32 v36, v36, v32, s51
    v_mov_b32 v32, v148
    v_perm_b32 v148, v37, v33, s50
    v_perm_b32 v37, v37, v33, s51
    v_mov_b32 v33, v148
    v_perm_b32 v148, v38, v34, s50
    v_perm_b32 v38, v38, v34, s51
    v_mov_b32 v34, v148
    v_perm_b32 v148, v39, v35, s50
    v_perm_b32 v39, v39, v35, s51
    v_mov_b32 v35, v148
    s_waitcnt vmcnt(6)
    v_perm_b32 v148, v44, v40, s50
    v_perm_b32 v44, v44, v40, s51
    v_mov_b32 v40, v148
    v_perm_b32 v148, v45, v41, s50
    v_perm_b32 v45, v45, v41, s51
    v_mov_b32 v41, v148
    v_perm_b32 v148, v46, v42, s50
    v_perm_b32 v46, v46, v42, s51
    v_mov_b32 v42, v148
    v_perm_b32 v148, v47, v43, s50
    v_perm_b32 v47, v47, v43, s51
    v_mov_b32 v43, v148
    s_waitcnt vmcnt(4)
    v_perm_b32 v148, v52, v48, s50
    v_perm_b32 v52, v52, v48, s51
    v_mov_b32 v48, v148
    v_perm_b32 v148, v53, v49, s50
    v_perm_b32 v53, v53, v49, s51
    v_mov_b32 v49, v148
    v_perm_b32 v148, v54, v50, s50
    v_perm_b32 v54, v54, v50, s51
    v_mov_b32 v50, v148
    v_perm_b32 v148, v55, v51, s50
    v_perm_b32 v55, v55, v51, s51
    v_mov_b32 v51, v148
    s_waitcnt vmcnt(2)
    v_perm_b32 v148, v60, v56, s50
    v_perm_b32 v60, v60, v56, s51
    v_mov_b32 v56, v148
    v_perm_b32 v148, v61, v57, s50
    v_perm_b32 v61, v61, v57, s51
    v_mov_b32 v57, v148
    v_perm_b32 v148, v62, v58, s50
    v_perm_b32 v62, v62, v58, s51
    v_mov_b32 v58, v148
    v_perm_b32 v148, v63, v59, s50
    v_perm_b32 v63, v63, v59, s51
    v_mov_b32 v59, v148
    s_waitcnt vmcnt(0)
    v_perm_b32 v148, v68, v64, s50
    v_perm_b32 v68, v68, v64, s51
    v_mov_b32 v64, v148
    v_perm_b32 v148, v69, v65, s50
    v_perm_b32 v69, v69, v65, s51
    v_mov_b32 v65, v148
    v_perm_b32 v148, v70, v66, s50
    v_perm_b32 v70, v70, v66, s51
    v_mov_b32 v66, v148
    v_perm_b32 v148, v71, v67, s50
    v_perm_b32 v71, v71, v67, s51
    v_mov_b32 v67, v148
    v_mov_b32 v165, 0
    s_mov_b32 s58, 0
L_lw_46:
    ds_read_b32 v164, v165 offset:28
    s_add_u32 s58, s58, 1
    s_waitcnt lgkmcnt(0)
    v_readfirstlane_b32 s62, v164
    s_nop 1
    s_cmp_ge_u32 s62, 1
    s_nop 0
    s_cbranch_scc1 L_lwd_47
    s_sleep 1
    s_cmp_lt_u32 s58, 0x400000
    s_cbranch_scc1 L_lw_46
L_lwd_47:
    s_lshl_b32 s80, s78, 14
    s_add_u32 s80, s80, 0x100000
    s_add_u32 s91, s80, 4096
    s_add_u32 s92, s80, 8192
    s_add_u32 s93, s80, 12288
    s_lshl_b32 s82, s78, 8
    s_add_u32 s82, s82, 0x180000
    v_lshlrev_b32 v148, 4, v1
    v_and_b32 v149, 15, v1
    v_lshlrev_b32 v149, 4, v149
    s_mov_b32 s58, 0
L_x2_r_48:
    buffer_load_dwordx4 v[144:147], v149, s[44:47], s82 offen sc1
    buffer_load_dwordx4 v[80:83], v148, s[44:47], s80 offen offset:0 sc1
    buffer_load_dwordx4 v[84:87], v148, s[44:47], s80 offen offset:1024 sc1
    buffer_load_dwordx4 v[88:91], v148, s[44:47], s80 offen offset:2048 sc1
    buffer_load_dwordx4 v[92:95], v148, s[44:47], s80 offen offset:3072 sc1
    buffer_load_dwordx4 v[96:99], v148, s[44:47], s91 offen offset:0 sc1
    buffer_load_dwordx4 v[100:103], v148, s[44:47], s91 offen offset:1024 sc1
    buffer_load_dwordx4 v[104:107], v148, s[44:47], s91 offen offset:2048 sc1
    buffer_load_dwordx4 v[108:111], v148, s[44:47], s91 offen offset:3072 sc1
    buffer_load_dwordx4 v[112:115], v148, s[44:47], s92 offen offset:0 sc1
    buffer_load_dwordx4 v[116:119], v148, s[44:47], s92 offen offset:1024 sc1
    buffer_load_dwordx4 v[120:123], v148, s[44:47], s92 offen offset:2048 sc1
    buffer_load_dwordx4 v[124:127], v148, s[44:47], s92 offen offset:3072 sc1
    buffer_load_dwordx4 v[128:131], v148, s[44:47], s93 offen offset:0 sc1
    buffer_load_dwordx4 v[132:135], v148, s[44:47], s93 offen offset:1024 sc1
    buffer_load_dwordx4 v[136:139], v148, s[44:47], s93 offen offset:2048 sc1
    buffer_load_dwordx4 v[140:143], v148, s[44:47], s93 offen offset:3072 sc1
    s_add_u32 s58, s58, 1
    s_waitcnt vmcnt(0)
    v_cmp_ne_u64 s[64:65], s[48:49], v[146:147]
    v_cmp_ne_u64 vcc, s[48:49], v[82:83]
    s_nop 1
    s_or_b64 s[64:65], s[64:65], vcc
    v_cmp_ne_u64 vcc, s[48:49], v[86:87]
    s_nop 1
    s_or_b64 s[64:65], s[64:65], vcc
    v_cmp_ne_u64 vcc, s[48:49], v[90:91]
    s_nop 1
    s_or_b64 s[64:65], s[64:65], vcc
    v_cmp_ne_u64 vcc, s[48:49], v[94:95]
    s_nop 1
    s_or_b64 s[64:65], s[64:65], vcc
    v_cmp_ne_u64 vcc, s[48:49], v[98:99]
    s_nop 1
    s_or_b64 s[64:65], s[64:65], vcc
    v_cmp_ne_u64 vcc, s[48:49], v[102:103]
    s_nop 1
    s_or_b64 s[64:65], s[64:65], vcc
    v_cmp_ne_u64 vcc, s[48:49], v[106:107]
    s_nop 1
    s_or_b64 s[64:65], s[64:65], vcc
    v_cmp_ne_u64 vcc, s[48:49], v[110:111]
    s_nop 1
    s_or_b64 s[64:65], s[64:65], vcc
    v_cmp_ne_u64 vcc, s[48:49], v[114:115]
    s_nop 1
    s_or_b64 s[64:65], s[64:65], vcc
    v_cmp_ne_u64 vcc, s[48:49], v[118:119]
    s_nop 1
    s_or_b64 s[64:65], s[64:65], vcc
    v_cmp_ne_u64 vcc, s[48:49], v[122:123]
    s_nop 1
    s_or_b64 s[64:65], s[64:65], vcc
    v_cmp_ne_u64 vcc, s[48:49], v[126:127]
    s_nop 1
    s_or_b64 s[64:65], s[64:65], vcc
    v_cmp_ne_u64 vcc, s[48:49], v[130:131]
    s_nop 1
    s_or_b64 s[64:65], s[64:65], vcc
    v_cmp_ne_u64 vcc, s[48:49], v[134:135]
    s_nop 1
    s_or_b64 s[64:65], s[64:65], vcc
    v_cmp_ne_u64 vcc, s[48:49], v[138:139]
    s_nop 1
    s_or_b64 s[64:65], s[64:65], vcc
    v_cmp_ne_u64 vcc, s[48:49], v[142:143]
    s_nop 1
    s_or_b64 s[64:65], s[64:65], vcc
    s_cmp_eq_u64 s[64:65], 0
    s_cbranch_scc1 L_x2_ok_49
    s_cmp_lt_u32 s58, 0x40000
    s_cbranch_scc1 L_x2_r_48
L_x2_ok_49:
    v_max_f32_dpp v150, v144, v144 row_ror:1 row_mask:0xf bank_mask:0xf
    s_nop 1
    v_max_f32_dpp v150, v150, v150 row_ror:2 row_mask:0xf bank_mask:0xf
    s_nop 1
    v_max_f32_dpp v150, v150, v150 row_ror:4 row_mask:0xf bank_mask:0xf
    s_nop 1
    v_max_f32_dpp v150, v150, v150 row_ror:8 row_mask:0xf bank_mask:0xf
    v_sub_f32 v151, v144, v150
    v_mul_f32 v151, 0x3fb8aa3b, v151
    v_exp_f32 v151, v151
    s_nop 0
    v_mul_f32 v146, v151, v145
    s_nop 1
    v_add_f32_dpp v146, v146, v146 row_ror:1 row_mask:0xf bank_mask:0xf
    s_nop 1
    v_add_f32_dpp v146, v146, v146 row_ror:2 row_mask:0xf bank_mask:0xf
    s_nop 1
    v_add_f32_dpp v146, v146, v146 row_ror:4 row_mask:0xf bank_mask:0xf
    s_nop 1
    v_add_f32_dpp v146, v146, v146 row_ror:8 row_mask:0xf bank_mask:0xf
    v_rcp_f32 v146, v146
    s_nop 0
    v_mul_f32 v151, v151, v146
    s_nop 1
    v_mul_f32_dpp v144, v151, v80 row_newbcast:0 row_mask:0xf bank_mask:0xf
    v_mul_f32_dpp v145, v151, v81 row_newbcast:0 row_mask:0xf bank_mask:0xf
    s_nop 0
    v_fmac_f32_dpp v144, v151, v84 row_newbcast:1 row_mask:0xf bank_mask:0xf
    v_fmac_f32_dpp v145, v151, v85 row_newbcast:1 row_mask:0xf bank_mask:0xf
    s_nop 0
    v_fmac_f32_dpp v144, v151, v88 row_newbcast:2 row_mask:0xf bank_mask:0xf
    v_fmac_f32_dpp v145, v151, v89 row_newbcast:2 row_mask:0xf bank_mask:0xf
    s_nop 0
    v_fmac_f32_dpp v144, v151, v92 row_newbcast:3 row_mask:0xf bank_mask:0xf
    v_fmac_f32_dpp v145, v151, v93 row_newbcast:3 row_mask:0xf bank_mask:0xf
    s_nop 0
    v_fmac_f32_dpp v144, v151, v96 row_newbcast:4 row_mask:0xf bank_mask:0xf
    v_fmac_f32_dpp v145, v151, v97 row_newbcast:4 row_mask:0xf bank_mask:0xf
    s_nop 0
    v_fmac_f32_dpp v144, v151, v100 row_newbcast:5 row_mask:0xf bank_mask:0xf
    v_fmac_f32_dpp v145, v151, v101 row_newbcast:5 row_mask:0xf bank_mask:0xf
    s_nop 0
    v_fmac_f32_dpp v144, v151, v104 row_newbcast:6 row_mask:0xf bank_mask:0xf
    v_fmac_f32_dpp v145, v151, v105 row_newbcast:6 row_mask:0xf bank_mask:0xf
    s_nop 0
    v_fmac_f32_dpp v144, v151, v108 row_newbcast:7 row_mask:0xf bank_mask:0xf
    v_fmac_f32_dpp v145, v151, v109 row_newbcast:7 row_mask:0xf bank_mask:0xf
    s_nop 0
    v_fmac_f32_dpp v144, v151, v112 row_newbcast:8 row_mask:0xf bank_mask:0xf
    v_fmac_f32_dpp v145, v151, v113 row_newbcast:8 row_mask:0xf bank_mask:0xf
    s_nop 0
    v_fmac_f32_dpp v144, v151, v116 row_newbcast:9 row_mask:0xf bank_mask:0xf
    v_fmac_f32_dpp v145, v151, v117 row_newbcast:9 row_mask:0xf bank_mask:0xf
    s_nop 0
    v_fmac_f32_dpp v144, v151, v120 row_newbcast:10 row_mask:0xf bank_mask:0xf
    v_fmac_f32_dpp v145, v151, v121 row_newbcast:10 row_mask:0xf bank_mask:0xf
    s_nop 0
    v_fmac_f32_dpp v144, v151, v124 row_newbcast:11 row_mask:0xf bank_mask:0xf
    v_fmac_f32_dpp v145, v151, v125 row_newbcast:11 row_mask:0xf bank_mask:0xf
    s_nop 0
    v_fmac_f32_dpp v144, v151, v128 row_newbcast:12 row_mask:0xf bank_mask:0xf
    v_fmac_f32_dpp v145, v151, v129 row_newbcast:12 row_mask:0xf bank_mask:0xf
    s_nop 0
    v_fmac_f32_dpp v144, v151, v132 row_newbcast:13 row_mask:0xf bank_mask:0xf
    v_fmac_f32_dpp v145, v151, v133 row_newbcast:13 row_mask:0xf bank_mask:0xf
    s_nop 0
    v_fmac_f32_dpp v144, v151, v136 row_newbcast:14 row_mask:0xf bank_mask:0xf
    v_fmac_f32_dpp v145, v151, v137 row_newbcast:14 row_mask:0xf bank_mask:0xf
    s_nop 0
    v_fmac_f32_dpp v144, v151, v140 row_newbcast:15 row_mask:0xf bank_mask:0xf
    v_fmac_f32_dpp v145, v151, v141 row_newbcast:15 row_mask:0xf bank_mask:0xf
    v_cvt_pk_bf16_f32 v144, v144, v145
    v_lshrrev_b32 v150, 3, v1
    v_lshlrev_b32 v150, 5, v150
    v_and_b32 v151, 3, v1
    v_lshl_add_u32 v150, v151, 3, v150
    v_bfe_u32 v151, v1, 2, 1
    v_lshl_add_u32 v150, v151, 1, v150
    v_add_u32 v150, s60, v150
    ds_write_b16 v150, v144
    ds_write_b16_d16_hi v150, v144 offset:4
    v_lshrrev_b32 v150, 3, v1
    v_lshlrev_b32 v150, 2, v150
    v_add_u32 v150, s60, v150
    ds_read_b32 v80, v150 offset:0
    ds_read_b32 v81, v150 offset:32
    ds_read_b32 v82, v150 offset:64
    ds_read_b32 v83, v150 offset:96
    ds_read_b32 v84, v150 offset:128
    ds_read_b32 v85, v150 offset:160
    ds_read_b32 v86, v150 offset:192
    ds_read_b32 v87, v150 offset:224
    s_waitcnt lgkmcnt(7)
    v_dot2_f32_bf16 v152, v8, v80, 0
    v_dot2_f32_bf16 v153, v12, v80, 0
    v_dot2_f32_bf16 v154, v9, v80, 0
    v_dot2_f32_bf16 v155, v13, v80, 0
    v_dot2_f32_bf16 v156, v10, v80, 0
    v_dot2_f32_bf16 v157, v14, v80, 0
    v_dot2_f32_bf16 v158, v11, v80, 0
    v_dot2_f32_bf16 v159, v15, v80, 0
    s_waitcnt lgkmcnt(6)
    v_dot2c_f32_bf16 v152, v16, v81
    v_dot2c_f32_bf16 v153, v20, v81
    v_dot2c_f32_bf16 v154, v17, v81
    v_dot2c_f32_bf16 v155, v21, v81
    v_dot2c_f32_bf16 v156, v18, v81
    v_dot2c_f32_bf16 v157, v22, v81
    v_dot2c_f32_bf16 v158, v19, v81
    v_dot2c_f32_bf16 v159, v23, v81
    s_waitcnt lgkmcnt(5)
    v_dot2c_f32_bf16 v152, v24, v82
    v_dot2c_f32_bf16 v153, v28, v82
    v_dot2c_f32_bf16 v154, v25, v82
    v_dot2c_f32_bf16 v155, v29, v82
    v_dot2c_f32_bf16 v156, v26, v82
    v_dot2c_f32_bf16 v157, v30, v82
    v_dot2c_f32_bf16 v158, v27, v82
    v_dot2c_f32_bf16 v159, v31, v82
    s_waitcnt lgkmcnt(4)
    v_dot2c_f32_bf16 v152, v32, v83
    v_dot2c_f32_bf16 v153, v36, v83
    v_dot2c_f32_bf16 v154, v33, v83
    v_dot2c_f32_bf16 v155, v37, v83
    v_dot2c_f32_bf16 v156, v34, v83
    v_dot2c_f32_bf16 v157, v38, v83
    v_dot2c_f32_bf16 v158, v35, v83
    v_dot2c_f32_bf16 v159, v39, v83
    s_waitcnt lgkmcnt(3)
    v_dot2c_f32_bf16 v152, v40, v84
    v_dot2c_f32_bf16 v153, v44, v84
    v_dot2c_f32_bf16 v154, v41, v84
    v_dot2c_f32_bf16 v155, v45, v84
    v_dot2c_f32_bf16 v156, v42, v84
    v_dot2c_f32_bf16 v157, v46, v84
    v_dot2c_f32_bf16 v158, v43, v84
    v_dot2c_f32_bf16 v159, v47, v84
    s_waitcnt lgkmcnt(2)
    v_dot2c_f32_bf16 v152, v48, v85
    v_dot2c_f32_bf16 v153, v52, v85
    v_dot2c_f32_bf16 v154, v49, v85
    v_dot2c_f32_bf16 v155, v53, v85
    v_dot2c_f32_bf16 v156, v50, v85
    v_dot2c_f32_bf16 v157, v54, v85
    v_dot2c_f32_bf16 v158, v51, v85
    v_dot2c_f32_bf16 v159, v55, v85
    s_waitcnt lgkmcnt(1)
    v_dot2c_f32_bf16 v152, v56, v86
    v_dot2c_f32_bf16 v153, v60, v86
    v_dot2c_f32_bf16 v154, v57, v86
    v_dot2c_f32_bf16 v155, v61, v86
    v_dot2c_f32_bf16 v156, v58, v86
    v_dot2c_f32_bf16 v157, v62, v86
    v_dot2c_f32_bf16 v158, v59, v86
    v_dot2c_f32_bf16 v159, v63, v86
    s_waitcnt lgkmcnt(0)
    v_dot2c_f32_bf16 v152, v64, v87
    v_dot2c_f32_bf16 v153, v68, v87
    v_dot2c_f32_bf16 v154, v65, v87
    v_dot2c_f32_bf16 v155, v69, v87
    v_dot2c_f32_bf16 v156, v66, v87
    v_dot2c_f32_bf16 v157, v70, v87
    v_dot2c_f32_bf16 v158, v67, v87
    v_dot2c_f32_bf16 v159, v71, v87
    s_lshl_b32 s82, s79, 5
    s_add_u32 s82, s82, s78
    s_lshl_b32 s82, s82, 9
    s_add_u32 s82, s82, 0x190000
    v_permlane32_swap_b32 v152, v156
    v_permlane32_swap_b32 v153, v157
    v_permlane32_swap_b32 v154, v158
    v_permlane32_swap_b32 v155, v159
    v_add_f32 v152, v152, v156
    v_add_f32 v153, v153, v157
    v_add_f32 v154, v154, v158
    v_add_f32 v155, v155, v159
    s_nop 0
    v_permlane16_swap_b32 v152, v154
    v_permlane16_swap_b32 v153, v155
    v_add_f32 v152, v152, v154
    v_add_f32 v153, v153, v155
    s_nop 0
    v_add_f32_dpp v152, v152, v152 row_ror:8 row_mask:0xf bank_mask:0x3
    s_nop 1
    v_add_f32_dpp v152, v153, v153 row_ror:8 row_mask:0xf bank_mask:0xc
    v_mov_b32 v88, v152
    s_nop 0
    v_mov_b32_dpp v89, v152 row_ror:8 row_mask:0xf bank_mask:0xf
    v_mov_b32 v90, s48
    v_mov_b32 v91, s49
    v_and_b32 v92, 7, v1
    v_lshlrev_b32 v92, 6, v92
    v_lshrrev_b32 v93, 5, v1
    v_lshl_add_u32 v92, v93, 5, v92
    v_bfe_u32 v93, v1, 4, 1
    v_lshl_add_u32 v92, v93, 4, v92
    s_mov_b32 exec_lo, 0x00ff00ff
    s_mov_b32 exec_hi, 0x00ff00ff
    buffer_store_dwordx4 v[88:91], v92, s[44:47], s82 offen sc1
    s_mov_b64 exec, -1
    s_branch L_exit_recurrent_scan__sliding_block_cached__swiglu_ffn__decode_kernel
L_e2_33:
    s_cmp_lt_u32 s95, 32
    s_cbranch_scc1 L_exit_recurrent_scan__sliding_block_cached__swiglu_ffn__decode_kernel
    s_cmp_ge_u32 s95, 100
    s_cbranch_scc1 L_exit_recurrent_scan__sliding_block_cached__swiglu_ffn__decode_kernel
    s_add_u32 s61, s95, 224
    s_mul_i32 s78, s61, 7282
    s_lshr_b32 s78, s78, 16
    s_mul_i32 s79, s78, 9
    s_sub_u32 s79, s61, s79
    s_mul_i32 s80, s78, 147456
    s_lshl_b32 s82, s79, 7
    s_add_u32 s80, s80, s82
    v_lshrrev_b32 v163, 3, v1
    s_mov_b32 s63, 1152
    v_mul_lo_u32 v163, v163, s63
    v_and_b32 v164, 7, v1
    v_lshl_add_u32 v163, v164, 4, v163
    v_mov_b32 v165, 0
    s_mov_b32 s58, 0
L_lw_50:
    ds_read_b32 v164, v165 offset:24
    s_add_u32 s58, s58, 1
    s_waitcnt lgkmcnt(0)
    v_readfirstlane_b32 s62, v164
    s_nop 1
    s_cmp_ge_u32 s62, 3
    s_nop 0
    s_cbranch_scc1 L_lwd_51
    s_sleep 1
    s_cmp_lt_u32 s58, 0x400000
    s_cbranch_scc1 L_lw_50
L_lwd_51:
    buffer_load_dwordx4 v[8:11], v163, s[36:39], s80 offen nt
    s_add_u32 s80, s80, 9216
    buffer_load_dwordx4 v[12:15], v163, s[36:39], s80 offen nt
    s_add_u32 s80, s80, 9216
    buffer_load_dwordx4 v[16:19], v163, s[36:39], s80 offen nt
    s_add_u32 s80, s80, 9216
    buffer_load_dwordx4 v[20:23], v163, s[36:39], s80 offen nt
    s_add_u32 s80, s80, 9216
    buffer_load_dwordx4 v[24:27], v163, s[36:39], s80 offen nt
    s_add_u32 s80, s80, 9216
    buffer_load_dwordx4 v[28:31], v163, s[36:39], s80 offen nt
    s_add_u32 s80, s80, 9216
    buffer_load_dwordx4 v[32:35], v163, s[36:39], s80 offen nt
    s_add_u32 s80, s80, 9216
    buffer_load_dwordx4 v[36:39], v163, s[36:39], s80 offen nt
    s_add_u32 s80, s80, 9216
    buffer_load_dwordx4 v[40:43], v163, s[36:39], s80 offen nt
    s_add_u32 s80, s80, 9216
    buffer_load_dwordx4 v[44:47], v163, s[36:39], s80 offen nt
    s_add_u32 s80, s80, 9216
    buffer_load_dwordx4 v[48:51], v163, s[36:39], s80 offen nt
    s_add_u32 s80, s80, 9216
    buffer_load_dwordx4 v[52:55], v163, s[36:39], s80 offen nt
    s_add_u32 s80, s80, 9216
    buffer_load_dwordx4 v[56:59], v163, s[36:39], s80 offen nt
    s_add_u32 s80, s80, 9216
    buffer_load_dwordx4 v[60:63], v163, s[36:39], s80 offen nt
    s_add_u32 s80, s80, 9216
    buffer_load_dwordx4 v[64:67], v163, s[36:39], s80 offen nt
    s_add_u32 s80, s80, 9216
    buffer_load_dwordx4 v[68:71], v163, s[36:39], s80 offen nt
    v_mov_b32 v165, 0
    s_mov_b32 s58, 0
L_lw_52:
    ds_read_b32 v164, v165 offset:12
    s_add_u32 s58, s58, 1
    s_waitcnt lgkmcnt(0)
    v_readfirstlane_b32 s62, v164
    s_nop 1
    s_cmp_ge_u32 s62, 1
    s_nop 0
    s_cbranch_scc1 L_lwd_53
    s_sleep 1
    s_cmp_lt_u32 s58, 0x400000
    s_cbranch_scc1 L_lw_52
L_lwd_53:
    v_mov_b32 v166, 0
    ds_read_b64 v[164:165], v166 offset:16
    s_waitcnt lgkmcnt(0)
    v_readfirstlane_b32 s48, v164
    v_readfirstlane_b32 s49, v165
    s_waitcnt vmcnt(14)
    v_perm_b32 v144, v12, v8, s50
    v_perm_b32 v12, v12, v8, s51
    v_mov_b32 v8, v144
    v_perm_b32 v144, v13, v9, s50
    v_perm_b32 v13, v13, v9, s51
    v_mov_b32 v9, v144
    v_perm_b32 v144, v14, v10, s50
    v_perm_b32 v14, v14, v10, s51
    v_mov_b32 v10, v144
    v_perm_b32 v144, v15, v11, s50
    v_perm_b32 v15, v15, v11, s51
    v_mov_b32 v11, v144
    s_waitcnt vmcnt(12)
    v_perm_b32 v144, v20, v16, s50
    v_perm_b32 v20, v20, v16, s51
    v_mov_b32 v16, v144
    v_perm_b32 v144, v21, v17, s50
    v_perm_b32 v21, v21, v17, s51
    v_mov_b32 v17, v144
    v_perm_b32 v144, v22, v18, s50
    v_perm_b32 v22, v22, v18, s51
    v_mov_b32 v18, v144
    v_perm_b32 v144, v23, v19, s50
    v_perm_b32 v23, v23, v19, s51
    v_mov_b32 v19, v144
    s_waitcnt vmcnt(10)
    v_perm_b32 v144, v28, v24, s50
    v_perm_b32 v28, v28, v24, s51
    v_mov_b32 v24, v144
    v_perm_b32 v144, v29, v25, s50
    v_perm_b32 v29, v29, v25, s51
    v_mov_b32 v25, v144
    v_perm_b32 v144, v30, v26, s50
    v_perm_b32 v30, v30, v26, s51
    v_mov_b32 v26, v144
    v_perm_b32 v144, v31, v27, s50
    v_perm_b32 v31, v31, v27, s51
    v_mov_b32 v27, v144
    s_waitcnt vmcnt(8)
    v_perm_b32 v144, v36, v32, s50
    v_perm_b32 v36, v36, v32, s51
    v_mov_b32 v32, v144
    v_perm_b32 v144, v37, v33, s50
    v_perm_b32 v37, v37, v33, s51
    v_mov_b32 v33, v144
    v_perm_b32 v144, v38, v34, s50
    v_perm_b32 v38, v38, v34, s51
    v_mov_b32 v34, v144
    v_perm_b32 v144, v39, v35, s50
    v_perm_b32 v39, v39, v35, s51
    v_mov_b32 v35, v144
    s_waitcnt vmcnt(6)
    v_perm_b32 v144, v44, v40, s50
    v_perm_b32 v44, v44, v40, s51
    v_mov_b32 v40, v144
    v_perm_b32 v144, v45, v41, s50
    v_perm_b32 v45, v45, v41, s51
    v_mov_b32 v41, v144
    v_perm_b32 v144, v46, v42, s50
    v_perm_b32 v46, v46, v42, s51
    v_mov_b32 v42, v144
    v_perm_b32 v144, v47, v43, s50
    v_perm_b32 v47, v47, v43, s51
    v_mov_b32 v43, v144
    s_waitcnt vmcnt(4)
    v_perm_b32 v144, v52, v48, s50
    v_perm_b32 v52, v52, v48, s51
    v_mov_b32 v48, v144
    v_perm_b32 v144, v53, v49, s50
    v_perm_b32 v53, v53, v49, s51
    v_mov_b32 v49, v144
    v_perm_b32 v144, v54, v50, s50
    v_perm_b32 v54, v54, v50, s51
    v_mov_b32 v50, v144
    v_perm_b32 v144, v55, v51, s50
    v_perm_b32 v55, v55, v51, s51
    v_mov_b32 v51, v144
    s_waitcnt vmcnt(2)
    v_perm_b32 v144, v60, v56, s50
    v_perm_b32 v60, v60, v56, s51
    v_mov_b32 v56, v144
    v_perm_b32 v144, v61, v57, s50
    v_perm_b32 v61, v61, v57, s51
    v_mov_b32 v57, v144
    v_perm_b32 v144, v62, v58, s50
    v_perm_b32 v62, v62, v58, s51
    v_mov_b32 v58, v144
    v_perm_b32 v144, v63, v59, s50
    v_perm_b32 v63, v63, v59, s51
    v_mov_b32 v59, v144
    s_waitcnt vmcnt(0)
    v_perm_b32 v144, v68, v64, s50
    v_perm_b32 v68, v68, v64, s51
    v_mov_b32 v64, v144
    v_perm_b32 v144, v69, v65, s50
    v_perm_b32 v69, v69, v65, s51
    v_mov_b32 v65, v144
    v_perm_b32 v144, v70, v66, s50
    v_perm_b32 v70, v70, v66, s51
    v_mov_b32 v66, v144
    v_perm_b32 v144, v71, v67, s50
    v_perm_b32 v71, v71, v67, s51
    v_mov_b32 v67, v144
    s_lshl_b32 s80, s78, 13
    s_add_u32 s80, s80, 0x40000
    s_add_u32 s81, s80, 4096
    v_lshlrev_b32 v145, 4, v1
    s_mov_b32 s58, 0
L_x1f_r_54:
    buffer_load_dwordx4 v[80:83], v145, s[44:47], s80 offen offset:0 sc1
    buffer_load_dwordx4 v[84:87], v145, s[44:47], s80 offen offset:1024 sc1
    buffer_load_dwordx4 v[88:91], v145, s[44:47], s80 offen offset:2048 sc1
    buffer_load_dwordx4 v[92:95], v145, s[44:47], s80 offen offset:3072 sc1
    buffer_load_dwordx4 v[96:99], v145, s[44:47], s81 offen offset:0 sc1
    buffer_load_dwordx4 v[100:103], v145, s[44:47], s81 offen offset:1024 sc1
    buffer_load_dwordx4 v[104:107], v145, s[44:47], s81 offen offset:2048 sc1
    buffer_load_dwordx4 v[108:111], v145, s[44:47], s81 offen offset:3072 sc1
    s_add_u32 s58, s58, 1
    s_waitcnt vmcnt(0)
    v_cmp_ne_u64 s[64:65], s[48:49], v[82:83]
    v_cmp_ne_u64 vcc, s[48:49], v[86:87]
    s_nop 1
    s_or_b64 s[64:65], s[64:65], vcc
    v_cmp_ne_u64 vcc, s[48:49], v[90:91]
    s_nop 1
    s_or_b64 s[64:65], s[64:65], vcc
    v_cmp_ne_u64 vcc, s[48:49], v[94:95]
    s_nop 1
    s_or_b64 s[64:65], s[64:65], vcc
    v_cmp_ne_u64 vcc, s[48:49], v[98:99]
    s_nop 1
    s_or_b64 s[64:65], s[64:65], vcc
    v_cmp_ne_u64 vcc, s[48:49], v[102:103]
    s_nop 1
    s_or_b64 s[64:65], s[64:65], vcc
    v_cmp_ne_u64 vcc, s[48:49], v[106:107]
    s_nop 1
    s_or_b64 s[64:65], s[64:65], vcc
    v_cmp_ne_u64 vcc, s[48:49], v[110:111]
    s_nop 1
    s_or_b64 s[64:65], s[64:65], vcc
    s_cmp_eq_u64 s[64:65], 0
    s_cbranch_scc1 L_x1f_ok_55
    s_cmp_lt_u32 s58, 0x40000
    s_cbranch_scc1 L_x1f_r_54
L_x1f_ok_55:
    v_add_f32 v80, v80, v84
    v_add_f32 v81, v81, v85
    v_mov_b32 v120, v80
    s_nop 1
    v_permlane32_swap_b32 v80, v120
    v_add_f32 v80, v80, v120
    v_mov_b32 v121, v81
    s_nop 1
    v_permlane32_swap_b32 v81, v121
    v_add_f32 v81, v81, v121
    v_add_f32 v88, v88, v92
    v_add_f32 v89, v89, v93
    v_mov_b32 v120, v88
    s_nop 1
    v_permlane32_swap_b32 v88, v120
    v_add_f32 v88, v88, v120
    v_mov_b32 v121, v89
    s_nop 1
    v_permlane32_swap_b32 v89, v121
    v_add_f32 v89, v89, v121
    v_add_f32 v96, v96, v100
    v_add_f32 v97, v97, v101
    v_mov_b32 v120, v96
    s_nop 1
    v_permlane32_swap_b32 v96, v120
    v_add_f32 v96, v96, v120
    v_mov_b32 v121, v97
    s_nop 1
    v_permlane32_swap_b32 v97, v121
    v_add_f32 v97, v97, v121
    v_add_f32 v104, v104, v108
    v_add_f32 v105, v105, v109
    v_mov_b32 v120, v104
    s_nop 1
    v_permlane32_swap_b32 v104, v120
    v_add_f32 v104, v104, v120
    v_mov_b32 v121, v105
    s_nop 1
    v_permlane32_swap_b32 v105, v121
    v_add_f32 v105, v105, v121
    v_cvt_pk_bf16_f32 v80, v80, v80
    v_lshlrev_b32 v80, 16, v80
    v_cvt_pk_bf16_f32 v96, v96, v96
    v_lshlrev_b32 v96, 16, v96
    v_mul_f32 v120, 0xbfb8aa3b, v80
    v_exp_f32 v120, v120
    s_nop 0
    v_add_f32 v120, 1.0, v120
    v_rcp_f32 v120, v120
    s_nop 0
    v_mul_f32 v80, v80, v120
    v_cvt_pk_bf16_f32 v80, v80, v80
    v_lshlrev_b32 v80, 16, v80
    v_mul_f32 v80, v80, v96
    v_cvt_pk_bf16_f32 v81, v81, v81
    v_lshlrev_b32 v81, 16, v81
    v_cvt_pk_bf16_f32 v97, v97, v97
    v_lshlrev_b32 v97, 16, v97
    v_mul_f32 v120, 0xbfb8aa3b, v81
    v_exp_f32 v120, v120
    s_nop 0
    v_add_f32 v120, 1.0, v120
    v_rcp_f32 v120, v120
    s_nop 0
    v_mul_f32 v81, v81, v120
    v_cvt_pk_bf16_f32 v81, v81, v81
    v_lshlrev_b32 v81, 16, v81
    v_mul_f32 v81, v81, v97
    v_cvt_pk_bf16_f32 v80, v80, v81
    v_and_b32 v124, 31, v1
    v_lshrrev_b32 v126, 3, v124
    v_lshlrev_b32 v126, 5, v126
    v_and_b32 v127, 3, v124
    v_lshl_add_u32 v126, v127, 3, v126
    v_bfe_u32 v127, v124, 2, 1
    v_lshl_add_u32 v126, v127, 1, v126
    v_add_u32 v126, s60, v126
    ds_write_b16 v126, v80
    ds_write_b16_d16_hi v126, v80 offset:4
    v_cvt_pk_bf16_f32 v88, v88, v88
    v_lshlrev_b32 v88, 16, v88
    v_cvt_pk_bf16_f32 v104, v104, v104
    v_lshlrev_b32 v104, 16, v104
    v_mul_f32 v120, 0xbfb8aa3b, v88
    v_exp_f32 v120, v120
    s_nop 0
    v_add_f32 v120, 1.0, v120
    v_rcp_f32 v120, v120
    s_nop 0
    v_mul_f32 v88, v88, v120
    v_cvt_pk_bf16_f32 v88, v88, v88
    v_lshlrev_b32 v88, 16, v88
    v_mul_f32 v88, v88, v104
    v_cvt_pk_bf16_f32 v89, v89, v89
    v_lshlrev_b32 v89, 16, v89
    v_cvt_pk_bf16_f32 v105, v105, v105
    v_lshlrev_b32 v105, 16, v105
    v_mul_f32 v120, 0xbfb8aa3b, v89
    v_exp_f32 v120, v120
    s_nop 0
    v_add_f32 v120, 1.0, v120
    v_rcp_f32 v120, v120
    s_nop 0
    v_mul_f32 v89, v89, v120
    v_cvt_pk_bf16_f32 v89, v89, v89
    v_lshlrev_b32 v89, 16, v89
    v_mul_f32 v89, v89, v105
    v_cvt_pk_bf16_f32 v88, v88, v89
    v_and_b32 v124, 31, v1
    v_add_u32 v124, 32, v124
    v_lshrrev_b32 v126, 3, v124
    v_lshlrev_b32 v126, 5, v126
    v_and_b32 v127, 3, v124
    v_lshl_add_u32 v126, v127, 3, v126
    v_bfe_u32 v127, v124, 2, 1
    v_lshl_add_u32 v126, v127, 1, v126
    v_add_u32 v126, s60, v126
    ds_write_b16 v126, v88
    ds_write_b16_d16_hi v126, v88 offset:4
    v_lshrrev_b32 v126, 3, v1
    v_lshlrev_b32 v126, 2, v126
    v_add_u32 v126, s60, v126
    ds_read_b32 v128, v126 offset:0
    ds_read_b32 v129, v126 offset:32
    ds_read_b32 v130, v126 offset:64
    ds_read_b32 v131, v126 offset:96
    ds_read_b32 v132, v126 offset:128
    ds_read_b32 v133, v126 offset:160
    ds_read_b32 v134, v126 offset:192
    ds_read_b32 v135, v126 offset:224
    s_waitcnt lgkmcnt(7)
    v_dot2_f32_bf16 v152, v8, v128, 0
    v_dot2_f32_bf16 v153, v12, v128, 0
    v_dot2_f32_bf16 v154, v9, v128, 0
    v_dot2_f32_bf16 v155, v13, v128, 0
    v_dot2_f32_bf16 v156, v10, v128, 0
    v_dot2_f32_bf16 v157, v14, v128, 0
    v_dot2_f32_bf16 v158, v11, v128, 0
    v_dot2_f32_bf16 v159, v15, v128, 0
    s_waitcnt lgkmcnt(6)
    v_dot2c_f32_bf16 v152, v16, v129
    v_dot2c_f32_bf16 v153, v20, v129
    v_dot2c_f32_bf16 v154, v17, v129
    v_dot2c_f32_bf16 v155, v21, v129
    v_dot2c_f32_bf16 v156, v18, v129
    v_dot2c_f32_bf16 v157, v22, v129
    v_dot2c_f32_bf16 v158, v19, v129
    v_dot2c_f32_bf16 v159, v23, v129
    s_waitcnt lgkmcnt(5)
    v_dot2c_f32_bf16 v152, v24, v130
    v_dot2c_f32_bf16 v153, v28, v130
    v_dot2c_f32_bf16 v154, v25, v130
    v_dot2c_f32_bf16 v155, v29, v130
    v_dot2c_f32_bf16 v156, v26, v130
    v_dot2c_f32_bf16 v157, v30, v130
    v_dot2c_f32_bf16 v158, v27, v130
    v_dot2c_f32_bf16 v159, v31, v130
    s_waitcnt lgkmcnt(4)
    v_dot2c_f32_bf16 v152, v32, v131
    v_dot2c_f32_bf16 v153, v36, v131
    v_dot2c_f32_bf16 v154, v33, v131
    v_dot2c_f32_bf16 v155, v37, v131
    v_dot2c_f32_bf16 v156, v34, v131
    v_dot2c_f32_bf16 v157, v38, v131
    v_dot2c_f32_bf16 v158, v35, v131
    v_dot2c_f32_bf16 v159, v39, v131
    s_waitcnt lgkmcnt(3)
    v_dot2c_f32_bf16 v152, v40, v132
    v_dot2c_f32_bf16 v153, v44, v132
    v_dot2c_f32_bf16 v154, v41, v132
    v_dot2c_f32_bf16 v155, v45, v132
    v_dot2c_f32_bf16 v156, v42, v132
    v_dot2c_f32_bf16 v157, v46, v132
    v_dot2c_f32_bf16 v158, v43, v132
    v_dot2c_f32_bf16 v159, v47, v132
    s_waitcnt lgkmcnt(2)
    v_dot2c_f32_bf16 v152, v48, v133
    v_dot2c_f32_bf16 v153, v52, v133
    v_dot2c_f32_bf16 v154, v49, v133
    v_dot2c_f32_bf16 v155, v53, v133
    v_dot2c_f32_bf16 v156, v50, v133
    v_dot2c_f32_bf16 v157, v54, v133
    v_dot2c_f32_bf16 v158, v51, v133
    v_dot2c_f32_bf16 v159, v55, v133
    s_waitcnt lgkmcnt(1)
    v_dot2c_f32_bf16 v152, v56, v134
    v_dot2c_f32_bf16 v153, v60, v134
    v_dot2c_f32_bf16 v154, v57, v134
    v_dot2c_f32_bf16 v155, v61, v134
    v_dot2c_f32_bf16 v156, v58, v134
    v_dot2c_f32_bf16 v157, v62, v134
    v_dot2c_f32_bf16 v158, v59, v134
    v_dot2c_f32_bf16 v159, v63, v134
    s_waitcnt lgkmcnt(0)
    v_dot2c_f32_bf16 v152, v64, v135
    v_dot2c_f32_bf16 v153, v68, v135
    v_dot2c_f32_bf16 v154, v65, v135
    v_dot2c_f32_bf16 v155, v69, v135
    v_dot2c_f32_bf16 v156, v66, v135
    v_dot2c_f32_bf16 v157, v70, v135
    v_dot2c_f32_bf16 v158, v67, v135
    v_dot2c_f32_bf16 v159, v71, v135
    s_mul_i32 s82, s79, 36
    s_add_u32 s82, s82, s78
    s_lshl_b32 s82, s82, 9
    s_add_u32 s82, s82, 0x1c0000
    v_permlane32_swap_b32 v152, v156
    v_permlane32_swap_b32 v153, v157
    v_permlane32_swap_b32 v154, v158
    v_permlane32_swap_b32 v155, v159
    v_add_f32 v152, v152, v156
    v_add_f32 v153, v153, v157
    v_add_f32 v154, v154, v158
    v_add_f32 v155, v155, v159
    s_nop 0
    v_permlane16_swap_b32 v152, v154
    v_permlane16_swap_b32 v153, v155
    v_add_f32 v152, v152, v154
    v_add_f32 v153, v153, v155
    s_nop 0
    v_add_f32_dpp v152, v152, v152 row_ror:8 row_mask:0xf bank_mask:0x3
    s_nop 1
    v_add_f32_dpp v152, v153, v153 row_ror:8 row_mask:0xf bank_mask:0xc
    v_mov_b32 v136, v152
    s_nop 0
    v_mov_b32_dpp v137, v152 row_ror:8 row_mask:0xf bank_mask:0xf
    v_mov_b32 v138, s48
    v_mov_b32 v139, s49
    v_and_b32 v140, 7, v1
    v_lshlrev_b32 v140, 6, v140
    v_lshrrev_b32 v141, 5, v1
    v_lshl_add_u32 v140, v141, 5, v140
    v_bfe_u32 v141, v1, 4, 1
    v_lshl_add_u32 v140, v141, 4, v140
    s_mov_b32 exec_lo, 0x00ff00ff
    s_mov_b32 exec_hi, 0x00ff00ff
    buffer_store_dwordx4 v[136:139], v140, s[44:47], s82 offen sc1
    s_mov_b64 exec, -1
    s_branch L_exit_recurrent_scan__sliding_block_cached__swiglu_ffn__decode_kernel
L_t3_10:
    s_mov_b32 s95, s2
    s_mov_b32 s94, s2
    s_cmp_lt_u32 s95, 100
    s_cbranch_scc1 L_g3_56
    s_cmp_ge_u32 s95, 164
    s_cbranch_scc1 L_g3_56
    s_add_u32 s61, s95, 412
    s_and_b32 s72, s61, 3
    s_lshr_b32 s73, s61, 4
    s_bfe_u32 s74, s61, 0x10002
    s_lshl_b32 s70, s73, 1
    s_add_u32 s70, s70, s74
    s_lshl_b32 s70, s70, 7
    s_mul_i32 s75, s72, 1327104
    s_add_u32 s70, s70, s75
    s_mul_i32 s75, s72, 288
    s_add_u32 s75, s75, s60
    v_lshrrev_b32 v161, 3, v1
    v_lshlrev_b32 v161, 2, v161
    v_add_u32 v161, s75, v161
    ds_read_b32 v152, v161 offset:0
    ds_read_b32 v153, v161 offset:32
    ds_read_b32 v154, v161 offset:64
    ds_read_b32 v155, v161 offset:96
    ds_read_b32 v156, v161 offset:128
    ds_read_b32 v157, v161 offset:160
    ds_read_b32 v158, v161 offset:192
    ds_read_b32 v159, v161 offset:224
    ds_read_b32 v160, v161 offset:256
    v_mov_b32 v165, 0
    s_mov_b32 s58, 0
L_lw_57:
    ds_read_b32 v164, v165 offset:4
    s_add_u32 s58, s58, 1
    s_waitcnt lgkmcnt(0)
    v_readfirstlane_b32 s62, v164
    s_nop 1
    s_cmp_ge_u32 s62, 8
    s_nop 0
    s_cbranch_scc1 L_lwd_58
    s_sleep 1
    s_cmp_lt_u32 s58, 0x400000
    s_cbranch_scc1 L_lw_57
L_lwd_58:
    v_lshrrev_b32 v163, 3, v1
    s_mov_b32 s63, 9216
    v_mul_lo_u32 v163, v163, s63
    v_and_b32 v164, 7, v1
    v_lshl_add_u32 v163, v164, 4, v163
    s_bitcmp1_b32 s61, 3
    s_cbranch_scc1 L_gup_59
    buffer_load_dwordx4 v[8:11], v163, s[28:31], s70 offen nt
    s_add_u32 s70, s70, 73728
    buffer_load_dwordx4 v[12:15], v163, s[28:31], s70 offen nt
    s_add_u32 s70, s70, 73728
    buffer_load_dwordx4 v[16:19], v163, s[28:31], s70 offen nt
    s_add_u32 s70, s70, 73728
    buffer_load_dwordx4 v[20:23], v163, s[28:31], s70 offen nt
    s_add_u32 s70, s70, 73728
    buffer_load_dwordx4 v[24:27], v163, s[28:31], s70 offen nt
    s_add_u32 s70, s70, 73728
    buffer_load_dwordx4 v[28:31], v163, s[28:31], s70 offen nt
    s_add_u32 s70, s70, 73728
    buffer_load_dwordx4 v[32:35], v163, s[28:31], s70 offen nt
    s_add_u32 s70, s70, 73728
    buffer_load_dwordx4 v[36:39], v163, s[28:31], s70 offen nt
    s_add_u32 s70, s70, 73728
    buffer_load_dwordx4 v[40:43], v163, s[28:31], s70 offen nt
    s_add_u32 s70, s70, 73728
    buffer_load_dwordx4 v[44:47], v163, s[28:31], s70 offen nt
    s_add_u32 s70, s70, 73728
    buffer_load_dwordx4 v[48:51], v163, s[28:31], s70 offen nt
    s_add_u32 s70, s70, 73728
    buffer_load_dwordx4 v[52:55], v163, s[28:31], s70 offen nt
    s_add_u32 s70, s70, 73728
    buffer_load_dwordx4 v[56:59], v163, s[28:31], s70 offen nt
    s_add_u32 s70, s70, 73728
    buffer_load_dwordx4 v[60:63], v163, s[28:31], s70 offen nt
    s_add_u32 s70, s70, 73728
    buffer_load_dwordx4 v[64:67], v163, s[28:31], s70 offen nt
    s_add_u32 s70, s70, 73728
    buffer_load_dwordx4 v[68:71], v163, s[28:31], s70 offen nt
    s_add_u32 s70, s70, 73728
    buffer_load_dwordx4 v[72:75], v163, s[28:31], s70 offen nt
    s_add_u32 s70, s70, 73728
    buffer_load_dwordx4 v[76:79], v163, s[28:31], s70 offen nt
    s_branch L_gdn_60
L_gup_59:
    buffer_load_dwordx4 v[8:11], v163, s[32:35], s70 offen nt
    s_add_u32 s70, s70, 73728
    buffer_load_dwordx4 v[12:15], v163, s[32:35], s70 offen nt
    s_add_u32 s70, s70, 73728
    buffer_load_dwordx4 v[16:19], v163, s[32:35], s70 offen nt
    s_add_u32 s70, s70, 73728
    buffer_load_dwordx4 v[20:23], v163, s[32:35], s70 offen nt
    s_add_u32 s70, s70, 73728
    buffer_load_dwordx4 v[24:27], v163, s[32:35], s70 offen nt
    s_add_u32 s70, s70, 73728
    buffer_load_dwordx4 v[28:31], v163, s[32:35], s70 offen nt
    s_add_u32 s70, s70, 73728
    buffer_load_dwordx4 v[32:35], v163, s[32:35], s70 offen nt
    s_add_u32 s70, s70, 73728
    buffer_load_dwordx4 v[36:39], v163, s[32:35], s70 offen nt
    s_add_u32 s70, s70, 73728
    buffer_load_dwordx4 v[40:43], v163, s[32:35], s70 offen nt
    s_add_u32 s70, s70, 73728
    buffer_load_dwordx4 v[44:47], v163, s[32:35], s70 offen nt
    s_add_u32 s70, s70, 73728
    buffer_load_dwordx4 v[48:51], v163, s[32:35], s70 offen nt
    s_add_u32 s70, s70, 73728
    buffer_load_dwordx4 v[52:55], v163, s[32:35], s70 offen nt
    s_add_u32 s70, s70, 73728
    buffer_load_dwordx4 v[56:59], v163, s[32:35], s70 offen nt
    s_add_u32 s70, s70, 73728
    buffer_load_dwordx4 v[60:63], v163, s[32:35], s70 offen nt
    s_add_u32 s70, s70, 73728
    buffer_load_dwordx4 v[64:67], v163, s[32:35], s70 offen nt
    s_add_u32 s70, s70, 73728
    buffer_load_dwordx4 v[68:71], v163, s[32:35], s70 offen nt
    s_add_u32 s70, s70, 73728
    buffer_load_dwordx4 v[72:75], v163, s[32:35], s70 offen nt
    s_add_u32 s70, s70, 73728
    buffer_load_dwordx4 v[76:79], v163, s[32:35], s70 offen nt
L_gdn_60:
    v_mov_b32 v164, 0
    v_mov_b32 v165, 1
    s_mov_b64 exec, 1
    ds_add_u32 v164, v165 offset:24
    s_mov_b64 exec, -1
    s_waitcnt vmcnt(16)
    v_perm_b32 v161, v12, v8, s50
    v_perm_b32 v162, v12, v8, s51
    v_dot2_f32_bf16 v144, v161, v152, 0
    v_dot2_f32_bf16 v145, v162, v152, 0
    v_perm_b32 v161, v13, v9, s50
    v_perm_b32 v162, v13, v9, s51
    v_dot2_f32_bf16 v146, v161, v152, 0
    v_dot2_f32_bf16 v147, v162, v152, 0
    v_perm_b32 v161, v14, v10, s50
    v_perm_b32 v162, v14, v10, s51
    v_dot2_f32_bf16 v148, v161, v152, 0
    v_dot2_f32_bf16 v149, v162, v152, 0
    v_perm_b32 v161, v15, v11, s50
    v_perm_b32 v162, v15, v11, s51
    v_dot2_f32_bf16 v150, v161, v152, 0
    v_dot2_f32_bf16 v151, v162, v152, 0
    s_waitcnt vmcnt(14)
    v_perm_b32 v161, v20, v16, s50
    v_perm_b32 v162, v20, v16, s51
    v_dot2c_f32_bf16 v144, v161, v153
    v_dot2c_f32_bf16 v145, v162, v153
    v_perm_b32 v161, v21, v17, s50
    v_perm_b32 v162, v21, v17, s51
    v_dot2c_f32_bf16 v146, v161, v153
    v_dot2c_f32_bf16 v147, v162, v153
    v_perm_b32 v161, v22, v18, s50
    v_perm_b32 v162, v22, v18, s51
    v_dot2c_f32_bf16 v148, v161, v153
    v_dot2c_f32_bf16 v149, v162, v153
    v_perm_b32 v161, v23, v19, s50
    v_perm_b32 v162, v23, v19, s51
    v_dot2c_f32_bf16 v150, v161, v153
    v_dot2c_f32_bf16 v151, v162, v153
    s_waitcnt vmcnt(12)
    v_perm_b32 v161, v28, v24, s50
    v_perm_b32 v162, v28, v24, s51
    v_dot2c_f32_bf16 v144, v161, v154
    v_dot2c_f32_bf16 v145, v162, v154
    v_perm_b32 v161, v29, v25, s50
    v_perm_b32 v162, v29, v25, s51
    v_dot2c_f32_bf16 v146, v161, v154
    v_dot2c_f32_bf16 v147, v162, v154
    v_perm_b32 v161, v30, v26, s50
    v_perm_b32 v162, v30, v26, s51
    v_dot2c_f32_bf16 v148, v161, v154
    v_dot2c_f32_bf16 v149, v162, v154
    v_perm_b32 v161, v31, v27, s50
    v_perm_b32 v162, v31, v27, s51
    v_dot2c_f32_bf16 v150, v161, v154
    v_dot2c_f32_bf16 v151, v162, v154
    s_waitcnt vmcnt(10)
    v_perm_b32 v161, v36, v32, s50
    v_perm_b32 v162, v36, v32, s51
    v_dot2c_f32_bf16 v144, v161, v155
    v_dot2c_f32_bf16 v145, v162, v155
    v_perm_b32 v161, v37, v33, s50
    v_perm_b32 v162, v37, v33, s51
    v_dot2c_f32_bf16 v146, v161, v155
    v_dot2c_f32_bf16 v147, v162, v155
    v_perm_b32 v161, v38, v34, s50
    v_perm_b32 v162, v38, v34, s51
    v_dot2c_f32_bf16 v148, v161, v155
    v_dot2c_f32_bf16 v149, v162, v155
    v_perm_b32 v161, v39, v35, s50
    v_perm_b32 v162, v39, v35, s51
    v_dot2c_f32_bf16 v150, v161, v155
    v_dot2c_f32_bf16 v151, v162, v155
    s_waitcnt vmcnt(8)
    v_perm_b32 v161, v44, v40, s50
    v_perm_b32 v162, v44, v40, s51
    v_dot2c_f32_bf16 v144, v161, v156
    v_dot2c_f32_bf16 v145, v162, v156
    v_perm_b32 v161, v45, v41, s50
    v_perm_b32 v162, v45, v41, s51
    v_dot2c_f32_bf16 v146, v161, v156
    v_dot2c_f32_bf16 v147, v162, v156
    v_perm_b32 v161, v46, v42, s50
    v_perm_b32 v162, v46, v42, s51
    v_dot2c_f32_bf16 v148, v161, v156
    v_dot2c_f32_bf16 v149, v162, v156
    v_perm_b32 v161, v47, v43, s50
    v_perm_b32 v162, v47, v43, s51
    v_dot2c_f32_bf16 v150, v161, v156
    v_dot2c_f32_bf16 v151, v162, v156
    s_waitcnt vmcnt(6)
    v_perm_b32 v161, v52, v48, s50
    v_perm_b32 v162, v52, v48, s51
    v_dot2c_f32_bf16 v144, v161, v157
    v_dot2c_f32_bf16 v145, v162, v157
    v_perm_b32 v161, v53, v49, s50
    v_perm_b32 v162, v53, v49, s51
    v_dot2c_f32_bf16 v146, v161, v157
    v_dot2c_f32_bf16 v147, v162, v157
    v_perm_b32 v161, v54, v50, s50
    v_perm_b32 v162, v54, v50, s51
    v_dot2c_f32_bf16 v148, v161, v157
    v_dot2c_f32_bf16 v149, v162, v157
    v_perm_b32 v161, v55, v51, s50
    v_perm_b32 v162, v55, v51, s51
    v_dot2c_f32_bf16 v150, v161, v157
    v_dot2c_f32_bf16 v151, v162, v157
    s_waitcnt vmcnt(4)
    v_perm_b32 v161, v60, v56, s50
    v_perm_b32 v162, v60, v56, s51
    v_dot2c_f32_bf16 v144, v161, v158
    v_dot2c_f32_bf16 v145, v162, v158
    v_perm_b32 v161, v61, v57, s50
    v_perm_b32 v162, v61, v57, s51
    v_dot2c_f32_bf16 v146, v161, v158
    v_dot2c_f32_bf16 v147, v162, v158
    v_perm_b32 v161, v62, v58, s50
    v_perm_b32 v162, v62, v58, s51
    v_dot2c_f32_bf16 v148, v161, v158
    v_dot2c_f32_bf16 v149, v162, v158
    v_perm_b32 v161, v63, v59, s50
    v_perm_b32 v162, v63, v59, s51
    v_dot2c_f32_bf16 v150, v161, v158
    v_dot2c_f32_bf16 v151, v162, v158
    s_waitcnt vmcnt(2)
    v_perm_b32 v161, v68, v64, s50
    v_perm_b32 v162, v68, v64, s51
    v_dot2c_f32_bf16 v144, v161, v159
    v_dot2c_f32_bf16 v145, v162, v159
    v_perm_b32 v161, v69, v65, s50
    v_perm_b32 v162, v69, v65, s51
    v_dot2c_f32_bf16 v146, v161, v159
    v_dot2c_f32_bf16 v147, v162, v159
    v_perm_b32 v161, v70, v66, s50
    v_perm_b32 v162, v70, v66, s51
    v_dot2c_f32_bf16 v148, v161, v159
    v_dot2c_f32_bf16 v149, v162, v159
    v_perm_b32 v161, v71, v67, s50
    v_perm_b32 v162, v71, v67, s51
    v_dot2c_f32_bf16 v150, v161, v159
    v_dot2c_f32_bf16 v151, v162, v159
    s_waitcnt vmcnt(0)
    v_perm_b32 v161, v76, v72, s50
    v_perm_b32 v162, v76, v72, s51
    v_dot2c_f32_bf16 v144, v161, v160
    v_dot2c_f32_bf16 v145, v162, v160
    v_perm_b32 v161, v77, v73, s50
    v_perm_b32 v162, v77, v73, s51
    v_dot2c_f32_bf16 v146, v161, v160
    v_dot2c_f32_bf16 v147, v162, v160
    v_perm_b32 v161, v78, v74, s50
    v_perm_b32 v162, v78, v74, s51
    v_dot2c_f32_bf16 v148, v161, v160
    v_dot2c_f32_bf16 v149, v162, v160
    v_perm_b32 v161, v79, v75, s50
    v_perm_b32 v162, v79, v75, s51
    v_dot2c_f32_bf16 v150, v161, v160
    v_dot2c_f32_bf16 v151, v162, v160
    s_lshl_b32 s71, s61, 9
    s_add_u32 s71, s71, 0x40000
    v_mov_b32 v165, 0
    s_mov_b32 s58, 0
L_lw_61:
    ds_read_b32 v164, v165 offset:12
    s_add_u32 s58, s58, 1
    s_waitcnt lgkmcnt(0)
    v_readfirstlane_b32 s62, v164
    s_nop 1
    s_cmp_ge_u32 s62, 1
    s_nop 0
    s_cbranch_scc1 L_lwd_62
    s_sleep 1
    s_cmp_lt_u32 s58, 0x400000
    s_cbranch_scc1 L_lw_61
L_lwd_62:
    v_mov_b32 v166, 0
    ds_read_b64 v[164:165], v166 offset:16
    s_waitcnt lgkmcnt(0)
    v_readfirstlane_b32 s48, v164
    v_readfirstlane_b32 s49, v165
    v_permlane32_swap_b32 v144, v148
    v_permlane32_swap_b32 v145, v149
    v_permlane32_swap_b32 v146, v150
    v_permlane32_swap_b32 v147, v151
    v_add_f32 v144, v144, v148
    v_add_f32 v145, v145, v149
    v_add_f32 v146, v146, v150
    v_add_f32 v147, v147, v151
    s_nop 0
    v_permlane16_swap_b32 v144, v146
    v_permlane16_swap_b32 v145, v147
    v_add_f32 v144, v144, v146
    v_add_f32 v145, v145, v147
    s_nop 0
    v_add_f32_dpp v144, v144, v144 row_ror:8 row_mask:0xf bank_mask:0x3
    s_nop 1
    v_add_f32_dpp v144, v145, v145 row_ror:8 row_mask:0xf bank_mask:0xc
    v_mov_b32 v8, v144
    s_nop 0
    v_mov_b32_dpp v9, v144 row_ror:8 row_mask:0xf bank_mask:0xf
    v_mov_b32 v10, s48
    v_mov_b32 v11, s49
    v_and_b32 v12, 7, v1
    v_lshlrev_b32 v12, 6, v12
    v_lshrrev_b32 v13, 5, v1
    v_lshl_add_u32 v12, v13, 5, v12
    v_bfe_u32 v13, v1, 4, 1
    v_lshl_add_u32 v12, v13, 4, v12
    s_mov_b32 exec_lo, 0x00ff00ff
    s_mov_b32 exec_hi, 0x00ff00ff
    buffer_store_dwordx4 v[8:11], v12, s[44:47], s71 offen sc1
    s_mov_b64 exec, -1
    s_branch L_exit_recurrent_scan__sliding_block_cached__swiglu_ffn__decode_kernel
L_g3_56:
    v_mov_b32 v164, 0
    v_mov_b32 v165, 1
    s_mov_b64 exec, 1
    ds_add_u32 v164, v165 offset:24
    s_mov_b64 exec, -1
    s_cmp_lt_u32 s94, 164
    s_cbranch_scc1 L_exit_recurrent_scan__sliding_block_cached__swiglu_ffn__decode_kernel
    s_cmp_ge_u32 s94, 200
    s_cbranch_scc1 L_exit_recurrent_scan__sliding_block_cached__swiglu_ffn__decode_kernel
    s_sub_u32 s61, s94, 164
    s_lshr_b32 s70, s61, 2
    s_and_b32 s71, s61, 3
    v_and_b32 v69, 7, v1
    v_lshlrev_b32 v69, 2, v69
    s_lshl_b32 s72, s70, 7
    s_lshl_b32 s73, s71, 5
    s_add_u32 s72, s72, s73
    buffer_load_dword v68, v69, s[8:11], s72 offen
    v_mov_b32 v73, 0
    s_mov_b32 s58, 0
L_lw_63:
    ds_read_b32 v72, v73 offset:12
    s_add_u32 s58, s58, 1
    s_waitcnt lgkmcnt(0)
    v_readfirstlane_b32 s62, v72
    s_nop 1
    s_cmp_ge_u32 s62, 1
    s_nop 0
    s_cbranch_scc1 L_lwd_64
    s_sleep 1
    s_cmp_lt_u32 s58, 0x400000
    s_cbranch_scc1 L_lw_63
L_lwd_64:
    v_mov_b32 v74, 0
    ds_read_b64 v[72:73], v74 offset:16
    s_waitcnt lgkmcnt(0)
    v_readfirstlane_b32 s48, v72
    v_readfirstlane_b32 s49, v73
    v_mov_b32 v73, 0
    s_mov_b32 s58, 0
L_lw_65:
    ds_read_b32 v72, v73 offset:28
    s_add_u32 s58, s58, 1
    s_waitcnt lgkmcnt(0)
    v_readfirstlane_b32 s62, v72
    s_nop 1
    s_cmp_ge_u32 s62, 1
    s_nop 0
    s_cbranch_scc1 L_lwd_66
    s_sleep 1
    s_cmp_lt_u32 s58, 0x400000
    s_cbranch_scc1 L_lw_65
L_lwd_66:
    s_lshl_b32 s76, s70, 14
    s_lshl_b32 s77, s71, 7
    s_add_u32 s76, s76, s77
    s_add_u32 s76, s76, 0x190000
    s_add_u32 s77, s76, 4096
    s_add_u32 s78, s76, 8192
    s_add_u32 s79, s76, 12288
    s_mul_i32 s82, s70, 18432
    s_lshl_b32 s83, s71, 7
    s_add_u32 s82, s82, s83
    s_add_u32 s82, s82, 0x1c0000
    s_add_u32 s83, s82, 4096
    s_add_u32 s84, s82, 8192
    s_add_u32 s85, s82, 12288
    s_add_u32 s86, s82, 16384
    v_lshrrev_b32 v70, 3, v1
    v_and_b32 v71, 3, v70
    v_lshlrev_b32 v70, 9, v70
    v_lshlrev_b32 v71, 9, v71
    v_and_b32 v72, 7, v1
    v_lshl_add_u32 v70, v72, 4, v70
    v_lshl_add_u32 v71, v72, 4, v71
    s_mov_b32 s58, 0
L_x3_r_67:
    buffer_load_dwordx4 v[8:11], v70, s[44:47], s76 offen sc1
    buffer_load_dwordx4 v[12:15], v70, s[44:47], s77 offen sc1
    buffer_load_dwordx4 v[16:19], v70, s[44:47], s78 offen sc1
    buffer_load_dwordx4 v[20:23], v70, s[44:47], s79 offen sc1
    buffer_load_dwordx4 v[24:27], v70, s[44:47], s82 offen sc1
    buffer_load_dwordx4 v[28:31], v70, s[44:47], s83 offen sc1
    buffer_load_dwordx4 v[32:35], v70, s[44:47], s84 offen sc1
    buffer_load_dwordx4 v[36:39], v70, s[44:47], s85 offen sc1
    buffer_load_dwordx4 v[40:43], v71, s[44:47], s86 offen sc1
    s_add_u32 s58, s58, 1
    s_waitcnt vmcnt(0)
    v_cmp_ne_u64 s[64:65], s[48:49], v[10:11]
    v_cmp_ne_u64 vcc, s[48:49], v[14:15]
    s_nop 1
    s_or_b64 s[64:65], s[64:65], vcc
    v_cmp_ne_u64 vcc, s[48:49], v[18:19]
    s_nop 1
    s_or_b64 s[64:65], s[64:65], vcc
    v_cmp_ne_u64 vcc, s[48:49], v[22:23]
    s_nop 1
    s_or_b64 s[64:65], s[64:65], vcc
    v_cmp_ne_u64 vcc, s[48:49], v[26:27]
    s_nop 1
    s_or_b64 s[64:65], s[64:65], vcc
    v_cmp_ne_u64 vcc, s[48:49], v[30:31]
    s_nop 1
    s_or_b64 s[64:65], s[64:65], vcc
    v_cmp_ne_u64 vcc, s[48:49], v[34:35]
    s_nop 1
    s_or_b64 s[64:65], s[64:65], vcc
    v_cmp_ne_u64 vcc, s[48:49], v[38:39]
    s_nop 1
    s_or_b64 s[64:65], s[64:65], vcc
    v_cmp_ne_u64 vcc, s[48:49], v[42:43]
    s_nop 1
    s_or_b64 s[64:65], s[64:65], vcc
    s_cmp_eq_u64 s[64:65], 0
    s_cbranch_scc1 L_x3_ok_68
    s_cmp_lt_u32 s58, 0x40000
    s_cbranch_scc1 L_x3_r_67
L_x3_ok_68:
    v_cndmask_b32 v40, 0, v40, s[56:57]
    v_cndmask_b32 v41, 0, v41, s[56:57]
    v_add_f32 v8, v8, v12
    v_add_f32 v8, v8, v16
    v_add_f32 v8, v8, v20
    v_add_f32 v24, v24, v28
    v_add_f32 v24, v24, v32
    v_add_f32 v24, v24, v36
    v_add_f32 v24, v24, v40
    v_add_f32 v9, v9, v13
    v_add_f32 v9, v9, v17
    v_add_f32 v9, v9, v21
    v_add_f32 v25, v25, v29
    v_add_f32 v25, v25, v33
    v_add_f32 v25, v25, v37
    v_add_f32 v25, v25, v41
    v_add_f32_dpp v8, v8, v8 row_ror:8 row_mask:0xf bank_mask:0xf
    v_mov_b32 v72, v8
    s_nop 1
    v_permlane16_swap_b32 v8, v72
    v_add_f32 v8, v8, v72
    v_mov_b32 v72, v8
    s_nop 1
    v_permlane32_swap_b32 v8, v72
    v_add_f32 v8, v8, v72
    v_add_f32_dpp v9, v9, v9 row_ror:8 row_mask:0xf bank_mask:0xf
    v_mov_b32 v72, v9
    s_nop 1
    v_permlane16_swap_b32 v9, v72
    v_add_f32 v9, v9, v72
    v_mov_b32 v72, v9
    s_nop 1
    v_permlane32_swap_b32 v9, v72
    v_add_f32 v9, v9, v72
    v_add_f32_dpp v24, v24, v24 row_ror:8 row_mask:0xf bank_mask:0xf
    v_mov_b32 v72, v24
    s_nop 1
    v_permlane16_swap_b32 v24, v72
    v_add_f32 v24, v24, v72
    v_mov_b32 v72, v24
    s_nop 1
    v_permlane32_swap_b32 v24, v72
    v_add_f32 v24, v24, v72
    v_add_f32_dpp v25, v25, v25 row_ror:8 row_mask:0xf bank_mask:0xf
    v_mov_b32 v72, v25
    s_nop 1
    v_permlane16_swap_b32 v25, v72
    v_add_f32 v25, v25, v72
    v_mov_b32 v72, v25
    s_nop 1
    v_permlane32_swap_b32 v25, v72
    v_add_f32 v25, v25, v72
    v_lshlrev_b32 v48, 16, v68
    v_and_b32 v49, 0xffff0000, v68
    v_cvt_pk_bf16_f32 v8, v8, v8
    v_lshlrev_b32 v8, 16, v8
    v_cvt_pk_bf16_f32 v24, v24, v24
    v_lshlrev_b32 v24, 16, v24
    v_mul_f32 v72, 0xbfb8aa3b, v24
    v_exp_f32 v72, v72
    s_nop 0
    v_add_f32 v72, 1.0, v72
    v_rcp_f32 v72, v72
    s_nop 0
    v_mul_f32 v24, v24, v72
    v_cvt_pk_bf16_f32 v24, v24, v24
    v_lshlrev_b32 v24, 16, v24
    v_mul_f32 v8, v8, v24
    v_cvt_pk_bf16_f32 v8, v8, v8
    v_lshlrev_b32 v8, 16, v8
    v_add_f32 v8, v48, v8
    v_cvt_pk_bf16_f32 v9, v9, v9
    v_lshlrev_b32 v9, 16, v9
    v_cvt_pk_bf16_f32 v25, v25, v25
    v_lshlrev_b32 v25, 16, v25
    v_mul_f32 v72, 0xbfb8aa3b, v25
    v_exp_f32 v72, v72
    s_nop 0
    v_add_f32 v72, 1.0, v72
    v_rcp_f32 v72, v72
    s_nop 0
    v_mul_f32 v25, v25, v72
    v_cvt_pk_bf16_f32 v25, v25, v25
    v_lshlrev_b32 v25, 16, v25
    v_mul_f32 v9, v9, v25
    v_cvt_pk_bf16_f32 v9, v9, v9
    v_lshlrev_b32 v9, 16, v9
    v_add_f32 v9, v49, v9
    v_cvt_pk_bf16_f32 v8, v8, v9
    s_mov_b64 exec, 0xff
    buffer_store_dword v8, v69, s[40:43], s72 offen
    s_mov_b64 exec, -1
    s_cmp_lg_u32 s61, 0
    s_cbranch_scc1 L_noep_69
    v_mov_b32 v52, s48
    v_mov_b32 v53, s49
    v_mov_b32 v54, 0
    s_mov_b64 exec, 1
    buffer_store_dwordx2 v[52:53], v54, s[44:47], 0 offen offset:0 sc1
    s_mov_b64 exec, -1
L_noep_69:
L_exit_recurrent_scan__sliding_block_cached__swiglu_ffn__decode_kernel:
L_end_recurrent_scan__sliding_block_cached__swiglu_ffn__decode_kernel:
    s_endpgm
.section .rodata,"a"
.p2align 6
.amdhsa_kernel recurrent_scan__sliding_block_cached__swiglu_ffn__decode_kernel
  .amdhsa_next_free_vgpr 168
  .amdhsa_next_free_sgpr 102
  .amdhsa_accum_offset 168
  .amdhsa_group_segment_fixed_size 0
  .amdhsa_kernarg_size 96
  .amdhsa_user_sgpr_count 2
  .amdhsa_user_sgpr_kernarg_segment_ptr 1
  .amdhsa_system_sgpr_workgroup_id_x 1
.end_amdhsa_kernel
```
